```python
import torch

def _softmax(x, axis=-1):
    return torch.softmax(x, dim=axis)
def _gelu(x):
    return torch.nn.functional.gelu(x, approximate="tanh")
def _silu(x):
    return torch.nn.functional.silu(x)
def _sigmoid(x):
    return torch.sigmoid(x)
def _layernorm(x, axis=-1, eps=1e-5):
    m = x.mean(dim=axis, keepdim=True)
    v = x.var(dim=axis, keepdim=True, unbiased=False)
    return (x - m) / torch.sqrt(v + eps)
def _scatter_add(tgt, idx, src, axis=0):
    return tgt.clone().index_add_(axis, idx, src)
def _segment_sum(src, seg, n):
    out = torch.zeros((n,) + src.shape[1:], dtype=src.dtype)
    return out.index_add_(0, seg, src)
def _pad(x, pw):
    flat = tuple(v for pair in reversed(pw) for v in pair)
    return torch.nn.functional.pad(x, flat)

kernel_name = 'recurrent_scan__sliding_block_cached__mixer_channel_mlp__decode'

def setup_inputs():

    _w = (lambda a: (lambda t: t.to(torch.bfloat16) if t.is_floating_point() else t)(torch.as_tensor(a)))
    def _A_setup():
        B, Sq, D = 2, 1, 1024
        Hq, Hkv, Sk, Dh = 32, 4, 32768, 128
        assert Hq % Hkv == 0, (Hq, Hkv)
        return {
            "x": _w((lambda *s: torch.randn(*s, dtype=torch.bfloat16) * 0.1)(B, Sq, D)),
            "k_cache": _w((lambda *s: torch.randn(*s, dtype=torch.bfloat16) * 0.8)(B, Hkv, Sk, Dh)),
            "v_cache": _w((lambda *s: torch.randn(*s, dtype=torch.bfloat16) * 3.2)(B, Hkv, Sk, Dh)),
            "wq": _w((lambda *s: torch.randn(*s, dtype=torch.bfloat16) * 0.8)(D, Hq * Dh) * (D ** -0.5)),
            "wo": _w((lambda *s: torch.randn(*s, dtype=torch.bfloat16) * 3.2)(Hq * Dh, D) * ((Hq * Dh) ** -0.5)),
        }
    _A_in = _A_setup()

    def _B_setup():
        B, S, D, F = 2, 1, 1024, 3584
        return {
            "x": _w((lambda *s: torch.randn(*s, dtype=torch.bfloat16) * 0.1)(B, S, D)),
            "w1": _w((lambda *s: torch.randn(*s, dtype=torch.bfloat16) * 3.2)(D, F) * (D ** -0.5)),
            "b1": _w((lambda *s: torch.randn(*s, dtype=torch.bfloat16) * 3.2)(F)),
            "w2": _w((lambda *s: torch.randn(*s, dtype=torch.bfloat16) * 3.2)(F, D) * (F ** -0.5)),
            "b2": _w((lambda *s: torch.randn(*s, dtype=torch.bfloat16) * 3.2)(D)),
        }
    _B_in = _B_setup()

    return {
        "A_x": _A_in["x"],
        "A_k_cache": _A_in["k_cache"],
        "A_v_cache": _A_in["v_cache"],
        "A_wq": _A_in["wq"],
        "A_wo": _A_in["wo"],
        "B_x": _B_in["x"],
        "B_w1": _B_in["w1"],
        "B_b1": _B_in["b1"],
        "B_w2": _B_in["w2"],
        "B_b2": _B_in["b2"],
    }

def reference(A_x, A_k_cache, A_v_cache, A_wq, A_wo, B_x, B_w1, B_b1, B_w2, B_b2):
    def _A_ref(x, k_cache, v_cache, wq, wo):
        B, Sq, D = x.shape
        Hq, Dh = 32, 128
        Hkv, Sk = k_cache.shape[1], k_cache.shape[2]
        W = min(4096, max(256, Sk // 4))
        rep = Hq // Hkv
        q = (lambda x, *d: x.permute(*d))((x @ wq).reshape(B, Sq, Hq, Dh), 0, 2, 1, 3)
        k = (lambda x, n, axis: torch.repeat_interleave(x, n, dim=axis))(k_cache[:, :, Sk - W:, :], rep, axis=1)
        v = (lambda x, n, axis: torch.repeat_interleave(x, n, dim=axis))(v_cache[:, :, Sk - W:, :], rep, axis=1)
        scores = torch.einsum("bhqd,bhkd->bhqk", q, k) * (Dh ** -0.5)
        p = _softmax(scores, axis=-1)
        o = torch.einsum("bhqk,bhkd->bhqd", p, v)
        return (lambda x, *d: x.permute(*d))(o, 0, 2, 1, 3).reshape(B, Sq, Hq * Dh) @ wo

    def _B_ref(x, w1, b1, w2, b2):
        y = _layernorm(x, axis=-1)
        h = _gelu(torch.einsum("bsd,df->bsf", y, w1) + b1)
        return torch.einsum("bsf,fd->bsd", h, w2) + b2

    x = A_x
    xn = _layernorm(x, axis=-1)
    s = _A_ref(xn, A_k_cache, A_v_cache, A_wq, A_wo)
    g = _silu(_B_ref(xn, B_w1, B_b1, B_w2, B_b2))
    return x + s * g
```

```asm
; @launch grid=(256,1,1) block=(768,1,1) lds=155648
.amdgcn_target "amdgcn-amd-amdhsa--gfx950"
.text
.globl recurrent_scan__sliding_block_cached__mixer_channel_mlp__decode_kernel
.p2align 8
.type recurrent_scan__sliding_block_cached__mixer_channel_mlp__decode_kernel,@function
recurrent_scan__sliding_block_cached__mixer_channel_mlp__decode_kernel:
    s_load_dwordx2 s[8:9], s[0:1], 0
    s_load_dwordx2 s[40:41], s[0:1], 24
    s_load_dwordx2 s[12:13], s[0:1], 96
    v_lshrrev_b32 v1, 6, v0
    s_lshr_b32 s6, s2, 3
    v_readfirstlane_b32 s3, v1
    s_cmp_ge_u32 s6, 32
    s_cbranch_scc1 L_end
    s_and_b32 s4, s2, 7
    s_lshl_b32 s4, s4, 5
    s_or_b32 s4, s4, s6
    s_cmp_ge_u32 s3, 4
    s_cbranch_scc1 L_notL
    v_lshlrev_b32 v5, 4, v0
    v_bfe_u32 v1, v0, 3, 3
    v_and_b32 v2, 6, v1
    v_xor_b32 v2, v0, v2
    v_and_b32 v2, 7, v2
    v_lshlrev_b32 v2, 4, v2
    v_lshl_add_u32 v3, v1, 13, v2
    s_lshr_b32 s7, s4, 4
    s_and_b32 s60, s7, 3
    s_lshl2_add_u32 s60, s60, s3
    s_lshl_b32 s60, s60, 10
    s_and_b32 s7, s7, 12
    s_add_u32 s60, s60, s7
    s_and_b32 s6, s6, 15
    s_lshl2_add_u32 s60, s60, s6
    s_lshl_b32 s44, s60, 7
    s_lshl_b32 s7, s3, 10
    s_lshl_b32 s59, s3, 13
    s_add_u32 m0, s7, 17152
    s_movk_i32 s10, 0x1000
    s_mov_b32 s11, 0x20000
    s_mov_b32 s43, s11
    s_lshl_b32 s42, s11, 6
    s_waitcnt lgkmcnt(0)
    buffer_load_dwordx4 v5, s[8:11], 0 offen lds
    s_add_u32 m0, s59, 24576
    s_nop 0
    buffer_load_dwordx4 v3, s[40:43], s44 offen offset:0 nt lds
    s_add_u32 s44, s44, 261120
    buffer_load_dwordx4 v3, s[40:43], s44 offen offset:1024 nt lds
    s_add_u32 s44, s44, 4294769664
    buffer_load_dwordx4 v3, s[40:43], s44 offen offset:2048 nt lds
    s_add_u32 s44, s44, 261120
    buffer_load_dwordx4 v3, s[40:43], s44 offen offset:3072 nt lds
    s_add_u32 m0, m0, s10
    s_add_u32 s44, s44, 4294773760
    buffer_load_dwordx4 v3, s[40:43], s44 offen offset:0 nt lds
    s_add_u32 s44, s44, 261120
    buffer_load_dwordx4 v3, s[40:43], s44 offen offset:1024 nt lds
    s_add_u32 s44, s44, 4294769664
    buffer_load_dwordx4 v3, s[40:43], s44 offen offset:2048 nt lds
    s_add_u32 s44, s44, 261120
    buffer_load_dwordx4 v3, s[40:43], s44 offen offset:3072 nt lds
    s_load_dwordx16 s[16:31], s[0:1], 8
L_Lmain:
    s_setprio 3
    s_mov_b32 s5, s3
    v_and_b32 v0, 63, v0
    s_mov_b32 s14, 2097152
    s_mov_b32 s15, 0x20000
    s_mov_b32 s58, 1048576
    v_mov_b32 v127, 0
    s_lshl_b32 s57, s5, 2
    v_mov_b32 v126, s57
    v_mul_u32_u24 v4, 7168, v1
    v_add_u32 v4, v4, v2
    v_lshrrev_b32 v1, 4, v0
    v_lshlrev_b32 v2, 1, v1
    v_xor_b32 v2, v0, v2
    v_and_b32 v2, 15, v2
    v_lshlrev_b32 v2, 4, v2
    v_lshl_add_u32 v5, v1, 8, v2
    v_xor_b32 v6, 0x80, v5
    v_lshl_add_u32 v7, v1, 11, v2
    s_and_b32 s57, s5, 1
    s_lshl_b32 s57, s57, 7
    v_xor_b32 v7, s57, v7
    v_xor_b32 v8, 0x80, v7
    s_bfe_u32 s6, s4, 0x10005
    s_lshr_b32 s7, s4, 6
    s_lshl2_add_u32 s6, s6, s7
    s_lshl_b32 s6, s6, 8
    s_and_b32 s7, s4, 31
    s_add_u32 s6, s6, s7
    s_add_u32 s6, s6, 224
    s_lshl_b32 s62, s6, 15
    s_add_u32 s62, s62, s59
    s_mov_b32 s57, s59
    v_and_b32 v2, 15, v0
    v_lshlrev_b32 v9, 4, v2
    v_lshl_add_u32 v9, v1, 14, v9
    v_and_b32 v10, 1, v1
    v_lshl_add_u32 v10, v2, 1, v10
    v_lshlrev_b32 v10, 5, v10
    v_lshrrev_b32 v11, 5, v0
    v_lshl_add_u32 v10, v11, 4, v10
    v_and_b32 v2, 1, v0
    v_lshlrev_b32 v2, 4, v2
    v_mov_b32 v1, 0x0f0e
    v_lshlrev_b32 v1, v2, v1
    v_mov_b32 v11, 0x0c0c0c0c
    v_xor_b32 v1, v11, v1
    v_bfe_u32 v2, v0, 1, 2
    v_cmp_eq_u32 vcc, 0, v2
    s_nop 1
    v_cndmask_b32 v12, v11, v1, vcc
    v_cmp_eq_u32 vcc, 1, v2
    s_nop 1
    v_cndmask_b32 v13, v11, v1, vcc
    v_cmp_eq_u32 vcc, 2, v2
    s_nop 1
    v_cndmask_b32 v14, v11, v1, vcc
    v_cmp_eq_u32 vcc, 3, v2
    s_nop 1
    v_cndmask_b32 v15, v11, v1, vcc
    s_lshr_b32 s6, s4, 5
    s_add_u32 s6, s6, 3
    s_and_b32 s6, s6, 7
    s_min_u32 s6, s6, 6
    s_and_b32 s7, s4, 7
    s_lshr_b32 s59, s7, 2
    s_sub_u32 s59, s7, s59
    s_bfe_u32 s60, s4, 0x20003
    s_lshl_b32 s60, s60, 1
    s_cmp_eq_u32 s7, 3
    s_cselect_b32 s59, s6, s59
    s_addc_u32 s60, s60, 0
    s_cmp_eq_u32 s59, s6
    s_cselect_b32 s61, 1, 0
    s_lshr_b32 s6, s4, 5
    s_mul_i32 s6, s6, 7
    s_add_u32 s59, s59, s6
    s_lshl_b32 s59, s59, 7
    s_lshr_b32 s49, s57, s61
    s_lshr_b32 s6, s49, 13
    s_lshl1_add_u32 s60, s60, s6
    s_mul_i32 s60, s60, 458752
    s_bfe_u32 s6, s49, 0x1000c
    s_mul_i32 s6, s6, 229376
    s_add_u32 s60, s60, s6
    s_add_u32 s63, s59, s60
    s_barrier
    s_waitcnt vmcnt(8)
    v_mov_b32 v125, 1
    s_mov_b64 exec, 1
    ds_write_b32 v126, v125
    s_mov_b64 exec, -1
    s_waitcnt lgkmcnt(0)
    s_mov_b64 s[8:9], s[16:17]
    s_mov_b32 s10, 67108864
    s_andn2_b32 s47, s62, 0xfffff
    s_and_b32 s7, s4, 31
    s_lshl_b32 s6, s7, 5
    s_add_u32 s6, s6, s5
    s_lshl_b32 s6, s6, 10
    s_bfe_u32 s96, s4, 196608
    s_add_u32 s47, s47, s6
    s_lshr_b32 s96, s4, 0
    s_mul_i32 s96, s96, 2654435761
    s_lshr_b32 s96, s96, 29
    s_lshl_b32 s96, s96, 12
    s_waitcnt vmcnt(5)
    s_xor_b32 s97, s96, 0
    s_add_u32 m0, s57, 57344
    s_add_u32 s97, s97, s47
    buffer_load_dwordx4 v5, s[8:11], s97 offen nt lds
    s_waitcnt vmcnt(5)
    s_xor_b32 s97, s96, 4096
    s_add_u32 m0, s57, 58368
    s_add_u32 s97, s97, s47
    buffer_load_dwordx4 v6, s[8:11], s97 offen nt lds
    s_waitcnt vmcnt(5)
    s_xor_b32 s97, s96, 8192
    s_add_u32 m0, s57, 59392
    s_add_u32 s97, s97, s47
    buffer_load_dwordx4 v5, s[8:11], s97 offen nt lds
    s_waitcnt vmcnt(5)
    s_xor_b32 s97, s96, 12288
    s_add_u32 m0, s57, 60416
    s_add_u32 s97, s97, s47
    buffer_load_dwordx4 v6, s[8:11], s97 offen nt lds
    s_waitcnt vmcnt(5)
    s_xor_b32 s97, s96, 16384
    s_add_u32 m0, s57, 61440
    s_add_u32 s97, s97, s47
    buffer_load_dwordx4 v5, s[8:11], s97 offen nt lds
    s_waitcnt vmcnt(5)
    v_mov_b32 v125, 9
    s_mov_b64 exec, 1
    ds_write_b32 v126, v125
    s_mov_b64 exec, -1
    s_xor_b32 s97, s96, 20480
    s_add_u32 m0, s57, 62464
    s_add_u32 s97, s97, s47
    buffer_load_dwordx4 v6, s[8:11], s97 offen nt lds
    s_waitcnt vmcnt(4)
    s_xor_b32 s97, s96, 24576
    s_add_u32 m0, s57, 63488
    s_add_u32 s97, s97, s47
    buffer_load_dwordx4 v5, s[8:11], s97 offen nt lds
    s_waitcnt vmcnt(4)
    s_xor_b32 s97, s96, 28672
    s_add_u32 m0, s57, 64512
    s_add_u32 s97, s97, s47
    buffer_load_dwordx4 v6, s[8:11], s97 offen nt lds
    s_mov_b64 s[40:41], s[18:19]
    s_mov_b32 s42, 67108864
    s_andn2_b32 s47, s62, 0xfffff
    s_and_b32 s7, s4, 31
    s_lshl_b32 s6, s7, 5
    s_add_u32 s6, s6, s5
    s_lshl_b32 s6, s6, 10
    s_bfe_u32 s96, s4, 196608
    s_add_u32 s47, s47, s6
    s_lshr_b32 s96, s4, 0
    s_mul_i32 s96, s96, 2654435761
    s_lshr_b32 s96, s96, 29
    s_lshl_b32 s96, s96, 12
    s_waitcnt vmcnt(4)
    s_xor_b32 s97, s96, 0
    s_add_u32 m0, s57, 90112
    s_add_u32 s97, s97, s47
    buffer_load_dwordx4 v5, s[40:43], s97 offen nt lds
    s_waitcnt vmcnt(4)
    s_xor_b32 s97, s96, 4096
    s_add_u32 m0, s57, 91136
    s_add_u32 s97, s97, s47
    buffer_load_dwordx4 v6, s[40:43], s97 offen nt lds
    s_waitcnt vmcnt(4)
    s_xor_b32 s97, s96, 8192
    s_add_u32 m0, s57, 92160
    s_add_u32 s97, s97, s47
    buffer_load_dwordx4 v5, s[40:43], s97 offen nt lds
    s_waitcnt vmcnt(4)
    v_mov_b32 v125, 16
    s_mov_b64 exec, 1
    ds_write_b32 v126, v125
    s_mov_b64 exec, -1
    s_xor_b32 s97, s96, 12288
    s_add_u32 m0, s57, 93184
    s_add_u32 s97, s97, s47
    buffer_load_dwordx4 v6, s[40:43], s97 offen nt lds
    s_waitcnt vmcnt(4)
    v_mov_b32 v125, 17
    s_mov_b64 exec, 1
    ds_write_b32 v126, v125
    s_mov_b64 exec, -1
    s_xor_b32 s97, s96, 16384
    s_add_u32 m0, s57, 94208
    s_add_u32 s97, s97, s47
    buffer_load_dwordx4 v5, s[40:43], s97 offen nt lds
    s_waitcnt vmcnt(4)
    s_xor_b32 s97, s96, 20480
    s_add_u32 m0, s57, 95232
    s_add_u32 s97, s97, s47
    buffer_load_dwordx4 v6, s[40:43], s97 offen nt lds
    s_waitcnt vmcnt(4)
    v_mov_b32 v125, 19
    s_mov_b64 exec, 1
    ds_write_b32 v126, v125
    s_mov_b64 exec, -1
    s_xor_b32 s97, s96, 24576
    s_add_u32 m0, s57, 96256
    s_add_u32 s97, s97, s47
    buffer_load_dwordx4 v5, s[40:43], s97 offen nt lds
    s_waitcnt vmcnt(4)
    s_xor_b32 s97, s96, 28672
    s_add_u32 m0, s57, 97280
    s_add_u32 s97, s97, s47
    buffer_load_dwordx4 v6, s[40:43], s97 offen nt lds
    s_mov_b64 s[8:9], s[26:27]
    s_mov_b32 s10, 7340032
    s_waitcnt vmcnt(4)
    s_add_u32 m0, s49, 122880
    s_nop 0
    buffer_load_dwordx4 v4, s[8:11], s63 offen offset:0 nt lds
    s_add_u32 s63, s63, 56320
    s_waitcnt vmcnt(4)
    buffer_load_dwordx4 v4, s[8:11], s63 offen offset:1024 nt lds
    s_add_u32 s63, s63, 56320
    s_waitcnt vmcnt(4)
    buffer_load_dwordx4 v4, s[8:11], s63 offen offset:2048 nt lds
    s_add_u32 s63, s63, 56320
    s_waitcnt vmcnt(4)
    buffer_load_dwordx4 v4, s[8:11], s63 offen offset:3072 nt lds
    s_add_u32 s63, s63, 60416
    s_waitcnt vmcnt(4)
    v_mov_b32 v125, 25
    s_mov_b64 exec, 1
    ds_write_b32 v126, v125
    s_mov_b64 exec, -1
    s_cmp_eq_u32 s61, 1
    s_cbranch_scc1 L_w1end
    s_add_u32 m0, m0, 4096
    s_nop 0
    buffer_load_dwordx4 v4, s[8:11], s63 offen offset:0 nt lds
    s_add_u32 s63, s63, 56320
    s_waitcnt vmcnt(4)
    buffer_load_dwordx4 v4, s[8:11], s63 offen offset:1024 nt lds
    s_add_u32 s63, s63, 56320
    s_waitcnt vmcnt(4)
    buffer_load_dwordx4 v4, s[8:11], s63 offen offset:2048 nt lds
    s_add_u32 s63, s63, 56320
    s_waitcnt vmcnt(4)
    buffer_load_dwordx4 v4, s[8:11], s63 offen offset:3072 nt lds
L_w1end:
    s_mov_b64 s[40:41], s[30:31]
    s_mov_b32 s42, 7340032
    s_setprio 2
L_w_1:
    ds_read_b128 v[120:123], v127 offset:16
    ds_read_b32 v114, v127 offset:72
    s_sub_u32 s58, s58, 1
    s_cbranch_scc1 L_end
    s_waitcnt lgkmcnt(1)
    v_min3_u32 v120, v120, v121, v122
    v_min_u32 v120, v120, v123
    v_cmp_gt_u32 vcc, 1, v120
    s_cbranch_vccnz L_w_1
    s_setprio 3
    s_lshr_b32 s6, s4, 3
    s_lshl2_add_u32 s6, s6, s5
    s_mul_i32 s6, s6, 57344
    s_and_b32 s7, s4, 7
    s_lshl_b32 s7, s7, 8
    s_add_u32 s60, s6, s7
    s_mul_i32 s7, s5, 7168
    s_waitcnt vmcnt(4)
    s_add_u32 m0, s7, 24576
    s_nop 0
    buffer_load_dwordx4 v7, s[40:43], s60 offen offset:0 nt lds
    s_add_u32 s60, s60, 7168
    s_waitcnt vmcnt(4)
    buffer_load_dwordx4 v8, s[40:43], s60 offen offset:1024 nt lds
    s_add_u32 s60, s60, 7168
    s_waitcnt vmcnt(4)
    buffer_load_dwordx4 v7, s[40:43], s60 offen offset:2048 nt lds
    s_add_u32 s60, s60, 7168
    s_waitcnt vmcnt(4)
    buffer_load_dwordx4 v8, s[40:43], s60 offen offset:3072 nt lds
    s_add_u32 s60, s60, 11264
    s_waitcnt vmcnt(4)
    v_mov_b32 v125, 33
    s_mov_b64 exec, 1
    ds_write_b32 v126, v125
    s_mov_b64 exec, -1
    s_add_u32 m0, m0, 4096
    s_nop 0
    buffer_load_dwordx4 v7, s[40:43], s60 offen offset:0 nt lds
    s_add_u32 s60, s60, 7168
    s_waitcnt vmcnt(4)
    buffer_load_dwordx4 v8, s[40:43], s60 offen offset:1024 nt lds
    s_add_u32 s60, s60, 7168
    s_waitcnt vmcnt(4)
    buffer_load_dwordx4 v7, s[40:43], s60 offen offset:2048 nt lds
    s_waitcnt lgkmcnt(0)
    v_readfirstlane_b32 s56, v114
    v_mov_b32 v124, 0xffffff00
    s_and_b32 s52, s56, 0xff
    s_bfe_u32 s53, s56, 0x80008
    s_bfe_u32 s54, s56, 0x80010
    s_lshr_b32 s55, s56, 24
    s_mov_b64 s[8:9], s[22:23]
    s_mov_b32 s10, 8388608
    s_and_b32 s7, s4, 31
    s_lshl2_add_u32 s60, s7, s5
    s_lshr_b32 s62, s4, 6
    s_bfe_u32 s61, s4, 0x10005
    s_lshl2_add_u32 s61, s61, s62
    s_lshl_b32 s6, s60, 8
    s_add_u32 s6, s6, s61
    s_lshl_b32 s6, s6, 8
    s_bfe_u32 s7, s60, 196608
    s_lshl_b32 s7, s7, 11
    s_add_u32 s6, s6, s7
    s_waitcnt vmcnt(4)
    buffer_load_dwordx4 v[16:19], v9, s[8:11], s6 offen nt
    s_xor_b32 s6, s6, 2048
    s_waitcnt vmcnt(4)
    buffer_load_dwordx4 v[20:23], v9, s[8:11], s6 offen nt
    s_xor_b32 s6, s6, 6144
    s_waitcnt vmcnt(4)
    buffer_load_dwordx4 v[24:27], v9, s[8:11], s6 offen nt
    s_xor_b32 s6, s6, 2048
    s_waitcnt vmcnt(4)
    buffer_load_dwordx4 v[28:31], v9, s[8:11], s6 offen nt
    s_xor_b32 s6, s6, 14336
    s_waitcnt vmcnt(4)
    v_mov_b32 v125, 40
    s_mov_b64 exec, 1
    ds_write_b32 v126, v125
    s_mov_b64 exec, -1
    s_setprio 1
L_rel_2:
    ds_read_b128 v[120:123], v127 offset:32
    ds_read_b32 v119, v127 offset:48
    s_sub_u32 s58, s58, 1
    s_cbranch_scc1 L_end
    s_waitcnt lgkmcnt(0)
    v_min3_u32 v120, v120, v121, v122
    v_min3_u32 v120, v120, v123, v119
    v_cmp_gt_u32 vcc, 3, v120
    s_cbranch_vccnz L_rel_2
    s_setprio 3
    s_waitcnt vmcnt(14)
    buffer_load_dwordx4 v[32:35], v9, s[8:11], s6 offen nt
    s_xor_b32 s6, s6, 2048
    s_waitcnt vmcnt(14)
    buffer_load_dwordx4 v[36:39], v9, s[8:11], s6 offen nt
    s_xor_b32 s6, s6, 6144
    s_waitcnt vmcnt(14)
    buffer_load_dwordx4 v[40:43], v9, s[8:11], s6 offen nt
    s_xor_b32 s6, s6, 2048
    s_waitcnt vmcnt(14)
    buffer_load_dwordx4 v[44:47], v9, s[8:11], s6 offen nt
    s_lshl_b32 s6, s4, 12
    v_lshlrev_b32 v8, 4, v0
    s_lshl_b32 s7, s5, 10
    v_add_u32 v9, s7, v8
    v_mov_b32 v11, 1
    s_add_u32 s63, s6, 1048576
    s_and_b32 s6, s4, 7
    s_lshl_b32 s6, s6, 7
    v_xor_b32 v10, s6, v10
    s_or_b32 s52, s52, 1
    s_and_b32 s6, s4, 31
    s_lshl3_add_u32 s6, s6, s5
    s_lshl_b32 s6, s6, 7
    s_add_u32 s97, s6, 786432
    s_and_b32 s48, s56, 0xffff
    s_branch L_px_3i
L_px_3:
    s_sub_u32 s58, s58, 16
    s_cmp_lt_i32 s58, 1047376
    s_cbranch_scc1 L_slow_4
L_bk_5:
L_px_3i:
    s_buffer_load_dwordx16 s[16:31], s[12:15], s97 offset:0 glc
    s_buffer_load_dwordx16 s[32:47], s[12:15], s97 offset:64 glc
    s_buffer_load_dwordx16 s[64:79], s[12:15], s97 offset:512 glc
    s_buffer_load_dwordx16 s[80:95], s[12:15], s97 offset:576 glc
    s_waitcnt lgkmcnt(0)
    s_xor_b32 s6, s16, s48
    s_xor_b32 s7, s32, s48
    s_or_b32 s6, s6, s7
    s_xor_b32 s7, s64, s48
    s_or_b32 s6, s6, s7
    s_xor_b32 s7, s80, s48
    s_or_b32 s6, s6, s7
    s_and_b32 s6, s6, 0xffff
    s_cbranch_scc1 L_px_3
    s_mov_b64 exec, 0xff
    v_mov_b64 v[48:49], s[16:17]
    v_mov_b64 v[50:51], s[18:19]
    v_mov_b64 v[52:53], s[20:21]
    v_mov_b64 v[54:55], s[22:23]
    s_lshl_b64 exec, exec, 8
    v_mov_b64 v[48:49], s[64:65]
    v_mov_b64 v[50:51], s[66:67]
    v_mov_b64 v[52:53], s[68:69]
    v_mov_b64 v[54:55], s[70:71]
    s_lshl_b64 exec, exec, 8
    v_mov_b64 v[48:49], s[24:25]
    v_mov_b64 v[50:51], s[26:27]
    v_mov_b64 v[52:53], s[28:29]
    v_mov_b64 v[54:55], s[30:31]
    s_lshl_b64 exec, exec, 8
    v_mov_b64 v[48:49], s[72:73]
    v_mov_b64 v[50:51], s[74:75]
    v_mov_b64 v[52:53], s[76:77]
    v_mov_b64 v[54:55], s[78:79]
    s_lshl_b64 exec, exec, 8
    v_mov_b64 v[48:49], s[32:33]
    v_mov_b64 v[50:51], s[34:35]
    v_mov_b64 v[52:53], s[36:37]
    v_mov_b64 v[54:55], s[38:39]
    s_lshl_b64 exec, exec, 8
    v_mov_b64 v[48:49], s[80:81]
    v_mov_b64 v[50:51], s[82:83]
    v_mov_b64 v[52:53], s[84:85]
    v_mov_b64 v[54:55], s[86:87]
    s_lshl_b64 exec, exec, 8
    v_mov_b64 v[48:49], s[40:41]
    v_mov_b64 v[50:51], s[42:43]
    v_mov_b64 v[52:53], s[44:45]
    v_mov_b64 v[54:55], s[46:47]
    s_lshl_b64 exec, exec, 8
    v_mov_b64 v[48:49], s[88:89]
    v_mov_b64 v[50:51], s[90:91]
    v_mov_b64 v[52:53], s[92:93]
    v_mov_b64 v[54:55], s[94:95]
    s_mov_b64 exec, -1
    v_perm_b32 v56, v48, v48, v12
    v_perm_b32 v57, v48, v48, v13
    v_perm_b32 v58, v48, v48, v14
    v_perm_b32 v59, v48, v48, v15
    v_perm_b32 v60, v49, v49, v12
    v_perm_b32 v61, v49, v49, v13
    v_perm_b32 v62, v49, v49, v14
    v_perm_b32 v63, v49, v49, v15
    s_waitcnt vmcnt(7)
    v_mfma_f32_16x16x32_bf16 v[4:7], v[56:59], v[16:19], 0
    v_perm_b32 v64, v50, v50, v12
    v_perm_b32 v65, v50, v50, v13
    v_perm_b32 v66, v50, v50, v14
    v_perm_b32 v67, v50, v50, v15
    s_waitcnt vmcnt(6)
    v_mfma_f32_16x16x32_bf16 v[4:7], v[60:63], v[20:23], v[4:7]
    v_perm_b32 v68, v51, v51, v12
    v_perm_b32 v69, v51, v51, v13
    v_perm_b32 v70, v51, v51, v14
    v_perm_b32 v71, v51, v51, v15
    s_waitcnt vmcnt(5)
    v_mfma_f32_16x16x32_bf16 v[4:7], v[64:67], v[24:27], v[4:7]
    v_perm_b32 v72, v52, v52, v12
    v_perm_b32 v73, v52, v52, v13
    v_perm_b32 v74, v52, v52, v14
    v_perm_b32 v75, v52, v52, v15
    s_waitcnt vmcnt(4)
    v_mfma_f32_16x16x32_bf16 v[4:7], v[68:71], v[28:31], v[4:7]
    v_perm_b32 v76, v53, v53, v12
    v_perm_b32 v77, v53, v53, v13
    v_perm_b32 v78, v53, v53, v14
    v_perm_b32 v79, v53, v53, v15
    s_waitcnt vmcnt(3)
    v_mfma_f32_16x16x32_bf16 v[4:7], v[72:75], v[32:35], v[4:7]
    v_perm_b32 v80, v54, v54, v12
    v_perm_b32 v81, v54, v54, v13
    v_perm_b32 v82, v54, v54, v14
    v_perm_b32 v83, v54, v54, v15
    s_waitcnt vmcnt(2)
    v_mfma_f32_16x16x32_bf16 v[4:7], v[76:79], v[36:39], v[4:7]
    v_perm_b32 v84, v55, v55, v12
    v_perm_b32 v85, v55, v55, v13
    v_perm_b32 v86, v55, v55, v14
    v_perm_b32 v87, v55, v55, v15
    v_xor_b32 v88, s48, v48
    v_bitop3_b32 v88, v49, s48, v88 bitop3:0xbe
    v_bitop3_b32 v88, v50, s48, v88 bitop3:0xbe
    v_bitop3_b32 v88, v51, s48, v88 bitop3:0xbe
    s_waitcnt vmcnt(1)
    v_mfma_f32_16x16x32_bf16 v[4:7], v[80:83], v[40:43], v[4:7]
    v_bitop3_b32 v88, v52, s48, v88 bitop3:0xbe
    v_bitop3_b32 v88, v53, s48, v88 bitop3:0xbe
    v_bitop3_b32 v88, v54, s48, v88 bitop3:0xbe
    v_bitop3_b32 v88, v55, s48, v88 bitop3:0xbe
    s_waitcnt vmcnt(0)
    v_mfma_f32_16x16x32_bf16 v[4:7], v[84:87], v[44:47], v[4:7]
    v_cmp_ne_u32_sdwa vcc, v88, v127 src0_sel:WORD_0 src1_sel:DWORD
    s_cbranch_vccnz L_px_3
    s_nop 5
    ds_write_b128 v9, v[4:7] offset:4608
    s_mov_b64 exec, 1
    ds_add_rtn_u32 v11, v127, v11 offset:68
    s_mov_b64 exec, -1
    ds_read_b128 v[16:19], v8 offset:4608
    ds_read_b128 v[20:23], v8 offset:5632
    ds_read_b128 v[24:27], v8 offset:6656
    ds_read_b128 v[28:31], v8 offset:7680
    s_waitcnt lgkmcnt(4)
    v_readfirstlane_b32 s6, v11
    s_nop 0
    s_cmp_eq_u32 s6, 3
    s_cbranch_scc0 L_nosp
    s_waitcnt lgkmcnt(2)
    v_pk_add_f32 v[16:17], v[16:17], v[20:21]
    v_pk_add_f32 v[18:19], v[18:19], v[22:23]
    s_waitcnt lgkmcnt(0)
    v_pk_add_f32 v[24:25], v[24:25], v[28:29]
    v_pk_add_f32 v[26:27], v[26:27], v[30:31]
    v_pk_add_f32 v[4:5], v[16:17], v[24:25]
    v_pk_add_f32 v[6:7], v[18:19], v[26:27]
    v_and_or_b32 v4, v4, v124, s52
    v_and_or_b32 v5, v5, v124, s53
    v_and_or_b32 v6, v6, v124, s54
    v_and_or_b32 v7, v7, v124, s55
    buffer_store_dwordx4 v[4:7], v10, s[12:15], s63 offen
L_nosp:
    v_mov_b32 v125, 64
    s_mov_b64 exec, 1
    ds_write_b32 v126, v125
    s_mov_b64 exec, -1
    s_branch L_fin
L_notL:
    s_cmp_eq_u32 s3, 10
    s_cbranch_scc0 L_noe
    s_waitcnt lgkmcnt(0)
    s_load_dword s57, s[12:13], 0
L_noe:
    v_and_b32 v0, 63, v0
    s_cmp_eq_u32 s3, 5
    s_cbranch_scc0 L_nopf
    s_getpc_b64 s[48:49]
L_pc:
    s_sub_u32 s48, s48, L_pc-L_Lmain-(512)
    s_subb_u32 s49, s49, 0
    v_lshl_add_u32 v1, v0, 5, s6
    v_cmp_gt_u32 vcc, (L_end-L_Lmain-(512))>>7, v1
    v_lshlrev_b32 v1, 7, v1
    v_mov_b32 v3, s49
    s_mov_b64 exec, vcc
    v_add_co_u32 v2, vcc, s48, v1
    s_nop 1
    v_addc_co_u32 v3, vcc, 0, v3, vcc
    global_load_dword v113, v[2:3], off offset:128
    s_mov_b64 exec, -1
L_nopf:
    v_mov_b32 v127, 0
    s_and_b32 s5, s3, 3
    s_cmp_eq_u32 s3, 4
    s_cbranch_scc0 L_noz
    v_lshlrev_b32 v2, 2, v0
    s_mov_b64 exec, 0x3ffff
    ds_write_b32 v2, v127
    s_mov_b64 exec, -1
    s_waitcnt lgkmcnt(0)
L_noz:
    s_mov_b32 s14, 2097152
    s_mov_b32 s15, 0x20000
    s_mov_b32 s58, 1048576
    s_lshl_b32 s6, s3, 2
    v_mov_b32 v126, s6
    s_and_b32 s6, s3, 14
    s_cmp_eq_u32 s6, 8
    s_cbranch_scc1 L_ln
    s_cmp_lt_u32 s3, 11
    s_cbranch_scc1 L_nopre
    s_load_dwordx16 s[16:31], s[0:1], 0
    s_load_dwordx8 s[32:39], s[0:1], 64
    s_lshr_b32 s6, s4, 5
    s_add_u32 s6, s6, 3
    s_and_b32 s6, s6, 7
    s_min_u32 s6, s6, 6
    s_and_b32 s7, s4, 7
    s_lshr_b32 s59, s7, 2
    s_sub_u32 s59, s7, s59
    s_bfe_u32 s60, s4, 0x20003
    s_lshl_b32 s60, s60, 1
    s_cmp_eq_u32 s7, 3
    s_cselect_b32 s59, s6, s59
    s_addc_u32 s60, s60, 0
    s_cmp_eq_u32 s59, s6
    s_cselect_b32 s61, 1, 0
    s_andn2_b32 s61, s61, s60
    s_cbranch_scc0 L_nopre
    s_mov_b64 exec, 15
    s_lshl_b32 s7, s4, 3
    v_lshl_add_u32 v11, v0, 21, s7
    v_mov_b32 v12, s7
    s_cmp_eq_u32 s60, 0
    s_cbranch_scc0 L_tlb1
    s_bfe_u32 s6, s4, 0x10005
    s_lshr_b32 s7, s4, 6
    s_lshl2_add_u32 s6, s6, s7
    s_lshl_b32 s6, s6, 8
    s_and_b32 s7, s4, 31
    s_add_u32 s6, s6, s7
    s_add_u32 s6, s6, 224
    s_lshl_b32 s60, s6, 15
    v_mov_b32 v10, s60
    s_setprio 3
    s_waitcnt lgkmcnt(0)
    global_load_dword v96, v10, s[18:19]
    s_barrier
    global_load_dword v97, v10, s[20:21]
    s_branch L_tlbe
L_tlb1:
    s_lshr_b32 s63, s4, 5
    s_mul_i32 s61, s63, 917504
    v_and_b32 v10, 1, v0
    v_mul_u32_u24 v10, 917500, v10
    v_add_u32 v10, s61, v10
    s_waitcnt lgkmcnt(0)
    s_barrier
    s_cmp_eq_u32 s60, 4
    s_cbranch_scc1 L_tlb2
    s_cmp_eq_u32 s60, 2
    s_cselect_b64 s[24:25], s[28:29], s[24:25]
    global_load_dword v96, v11, s[24:25]
    s_branch L_tlbe
L_tlb2:
    global_load_dword v96, v10, s[32:33]
    global_load_dword v97, v12, s[30:31]
L_tlbe:
    s_mov_b64 exec, -1
    s_branch L_Mmain
L_nopre:
    s_barrier
    s_cmp_lt_u32 s3, 8
    s_cbranch_scc1 L_A
    s_cmp_eq_u32 s5, 2
    s_cbranch_scc0 L_Mmain
    s_waitcnt lgkmcnt(0)
    s_add_u32 s6, s57, 2
    s_and_b32 s6, s6, 0xfe
    s_mul_i32 s57, s57, 1664525
    s_add_u32 s57, s57, 1013904223
    s_andn2_b32 s57, s57, 0xff
    s_or_b32 s57, s57, s6
    v_mov_b32 v2, s57
    ds_write_b32 v127, v2 offset:72
    v_mov_b32 v125, 2
    s_mov_b64 exec, 1
    ds_write_b32 v126, v125
    s_mov_b64 exec, -1
    s_branch L_Mmain
L_ln:
    v_lshlrev_b32 v1, 4, v0
    s_lshl_b32 s6, s5, 11
    v_add_u32 v2, s6, v1
    s_mul_i32 s6, s5, 2112
    s_add_u32 s6, s6, 4608
    v_add_u32 v1, s6, v1
    s_mov_b32 s60, 1
L_lntop:
    s_waitcnt lgkmcnt(0)
    s_barrier
    s_setprio 2
L_w_6:
    ds_read_b128 v[120:123], v127 offset:0
    ds_read_b128 v[4:7], v2 offset:17152
    ds_read_b128 v[8:11], v2 offset:18176
    s_sub_u32 s58, s58, 1
    s_cbranch_scc1 L_end
    s_waitcnt lgkmcnt(2)
    v_min3_u32 v120, v120, v121, v122
    v_min_u32 v120, v120, v123
    v_cmp_gt_u32 vcc, 1, v120
    s_cbranch_vccnz L_w_6
    s_setprio 3
    s_waitcnt lgkmcnt(0)
L_lnloop:
    v_lshlrev_b32 v16, 16, v4
    v_and_b32 v17, 0xffff0000, v4
    v_lshlrev_b32 v18, 16, v5
    v_and_b32 v19, 0xffff0000, v5
    v_lshlrev_b32 v20, 16, v6
    v_and_b32 v21, 0xffff0000, v6
    v_lshlrev_b32 v22, 16, v7
    v_and_b32 v23, 0xffff0000, v7
    v_lshlrev_b32 v24, 16, v8
    v_and_b32 v25, 0xffff0000, v8
    v_lshlrev_b32 v26, 16, v9
    v_and_b32 v27, 0xffff0000, v9
    v_lshlrev_b32 v28, 16, v10
    v_and_b32 v29, 0xffff0000, v10
    v_lshlrev_b32 v30, 16, v11
    v_and_b32 v31, 0xffff0000, v11
    v_pk_add_f32 v[32:33], v[16:17], v[18:19]
    v_pk_add_f32 v[34:35], v[20:21], v[22:23]
    v_pk_add_f32 v[36:37], v[24:25], v[26:27]
    v_pk_add_f32 v[38:39], v[28:29], v[30:31]
    v_pk_add_f32 v[32:33], v[32:33], v[34:35]
    v_pk_add_f32 v[36:37], v[36:37], v[38:39]
    v_pk_add_f32 v[32:33], v[32:33], v[36:37]
    v_add_f32 v12, v32, v33
    v_mov_b32 v13, v12
    s_nop 1
    v_permlane32_swap_b32 v12, v13
    v_add_f32 v12, v12, v13
    v_mov_b32 v13, v12
    s_nop 1
    v_permlane16_swap_b32 v12, v13
    v_add_f32 v12, v12, v13
    s_nop 1
    v_add_f32_dpp v12, v12, v12 row_ror:8 row_mask:0xf bank_mask:0xf
    s_nop 1
    v_add_f32_dpp v12, v12, v12 row_ror:4 row_mask:0xf bank_mask:0xf
    s_nop 1
    v_add_f32_dpp v12, v12, v12 row_ror:2 row_mask:0xf bank_mask:0xf
    s_nop 1
    v_add_f32_dpp v12, v12, v12 row_ror:1 row_mask:0xf bank_mask:0xf
    v_mul_f32 v12, 0x3a800000, v12
    v_pk_add_f32 v[32:33], v[16:17], v[12:13] op_sel_hi:[1,0] neg_lo:[0,1] neg_hi:[0,1]
    v_pk_add_f32 v[34:35], v[18:19], v[12:13] op_sel_hi:[1,0] neg_lo:[0,1] neg_hi:[0,1]
    v_pk_add_f32 v[36:37], v[20:21], v[12:13] op_sel_hi:[1,0] neg_lo:[0,1] neg_hi:[0,1]
    v_pk_add_f32 v[38:39], v[22:23], v[12:13] op_sel_hi:[1,0] neg_lo:[0,1] neg_hi:[0,1]
    v_pk_add_f32 v[40:41], v[24:25], v[12:13] op_sel_hi:[1,0] neg_lo:[0,1] neg_hi:[0,1]
    v_pk_add_f32 v[42:43], v[26:27], v[12:13] op_sel_hi:[1,0] neg_lo:[0,1] neg_hi:[0,1]
    v_pk_add_f32 v[44:45], v[28:29], v[12:13] op_sel_hi:[1,0] neg_lo:[0,1] neg_hi:[0,1]
    v_pk_add_f32 v[46:47], v[30:31], v[12:13] op_sel_hi:[1,0] neg_lo:[0,1] neg_hi:[0,1]
    v_pk_mul_f32 v[14:15], v[32:33], v[32:33]
    v_pk_mul_f32 v[48:49], v[34:35], v[34:35]
    v_pk_fma_f32 v[14:15], v[36:37], v[36:37], v[14:15]
    v_pk_fma_f32 v[48:49], v[38:39], v[38:39], v[48:49]
    v_pk_fma_f32 v[14:15], v[40:41], v[40:41], v[14:15]
    v_pk_fma_f32 v[48:49], v[42:43], v[42:43], v[48:49]
    v_pk_fma_f32 v[14:15], v[44:45], v[44:45], v[14:15]
    v_pk_fma_f32 v[48:49], v[46:47], v[46:47], v[48:49]
    v_pk_add_f32 v[14:15], v[14:15], v[48:49]
    v_cvt_pk_bf16_f32 v12, v12, v12
    v_and_b32 v12, 0xffff0000, v12
    v_add_f32 v14, v14, v15
    v_mov_b32 v15, v14
    v_pk_add_f32 v[32:33], v[16:17], v[12:13] op_sel_hi:[1,0] neg_lo:[0,1] neg_hi:[0,1]
    v_pk_add_f32 v[34:35], v[18:19], v[12:13] op_sel_hi:[1,0] neg_lo:[0,1] neg_hi:[0,1]
    v_permlane32_swap_b32 v14, v15
    v_add_f32 v14, v14, v15
    v_mov_b32 v15, v14
    v_pk_add_f32 v[36:37], v[20:21], v[12:13] op_sel_hi:[1,0] neg_lo:[0,1] neg_hi:[0,1]
    v_pk_add_f32 v[38:39], v[22:23], v[12:13] op_sel_hi:[1,0] neg_lo:[0,1] neg_hi:[0,1]
    v_permlane16_swap_b32 v14, v15
    v_add_f32 v14, v14, v15
    v_pk_add_f32 v[40:41], v[24:25], v[12:13] op_sel_hi:[1,0] neg_lo:[0,1] neg_hi:[0,1]
    v_pk_add_f32 v[42:43], v[26:27], v[12:13] op_sel_hi:[1,0] neg_lo:[0,1] neg_hi:[0,1]
    v_add_f32_dpp v14, v14, v14 row_ror:8 row_mask:0xf bank_mask:0xf
    v_pk_add_f32 v[44:45], v[28:29], v[12:13] op_sel_hi:[1,0] neg_lo:[0,1] neg_hi:[0,1]
    v_pk_add_f32 v[46:47], v[30:31], v[12:13] op_sel_hi:[1,0] neg_lo:[0,1] neg_hi:[0,1]
    v_add_f32_dpp v14, v14, v14 row_ror:4 row_mask:0xf bank_mask:0xf
    v_cvt_pk_bf16_f32 v4, v32, v33
    v_cvt_pk_bf16_f32 v5, v34, v35
    v_add_f32_dpp v14, v14, v14 row_ror:2 row_mask:0xf bank_mask:0xf
    v_cvt_pk_bf16_f32 v6, v36, v37
    v_cvt_pk_bf16_f32 v7, v38, v39
    v_add_f32_dpp v14, v14, v14 row_ror:1 row_mask:0xf bank_mask:0xf
    v_mul_f32 v14, 0x3a800000, v14
    v_cvt_pk_bf16_f32 v14, v14, v14
    v_and_b32 v14, 0xffff0000, v14
    v_add_f32 v14, 0x3727c5ac, v14
    v_cvt_pk_bf16_f32 v14, v14, v14
    v_and_b32 v14, 0xffff0000, v14
    v_sqrt_f32 v14, v14
    v_cvt_pk_bf16_f32 v8, v40, v41
    v_cvt_pk_bf16_f32 v9, v42, v43
    v_cvt_pk_bf16_f32 v10, v44, v45
    v_cvt_pk_bf16_f32 v11, v46, v47
    v_cvt_pk_bf16_f32 v14, v14, v14
    v_and_b32 v14, 0xffff0000, v14
    v_rcp_f32 v14, v14
    v_lshlrev_b32 v16, 16, v4
    v_and_b32 v17, 0xffff0000, v4
    v_lshlrev_b32 v18, 16, v5
    v_and_b32 v19, 0xffff0000, v5
    v_lshlrev_b32 v20, 16, v6
    v_and_b32 v21, 0xffff0000, v6
    v_lshlrev_b32 v22, 16, v7
    v_and_b32 v23, 0xffff0000, v7
    v_lshlrev_b32 v24, 16, v8
    v_and_b32 v25, 0xffff0000, v8
    v_lshlrev_b32 v26, 16, v9
    v_and_b32 v27, 0xffff0000, v9
    v_lshlrev_b32 v28, 16, v10
    v_and_b32 v29, 0xffff0000, v10
    v_lshlrev_b32 v30, 16, v11
    v_and_b32 v31, 0xffff0000, v11
    v_pk_mul_f32 v[16:17], v[16:17], v[14:15] op_sel_hi:[1,0]
    v_pk_mul_f32 v[18:19], v[18:19], v[14:15] op_sel_hi:[1,0]
    v_pk_mul_f32 v[20:21], v[20:21], v[14:15] op_sel_hi:[1,0]
    v_pk_mul_f32 v[22:23], v[22:23], v[14:15] op_sel_hi:[1,0]
    v_pk_mul_f32 v[24:25], v[24:25], v[14:15] op_sel_hi:[1,0]
    v_pk_mul_f32 v[26:27], v[26:27], v[14:15] op_sel_hi:[1,0]
    v_pk_mul_f32 v[28:29], v[28:29], v[14:15] op_sel_hi:[1,0]
    v_pk_mul_f32 v[30:31], v[30:31], v[14:15] op_sel_hi:[1,0]
    v_cvt_pk_bf16_f32 v4, v16, v17
    v_cvt_pk_bf16_f32 v5, v18, v19
    v_cvt_pk_bf16_f32 v6, v20, v21
    v_cvt_pk_bf16_f32 v7, v22, v23
    v_cvt_pk_bf16_f32 v8, v24, v25
    v_cvt_pk_bf16_f32 v9, v26, v27
    v_cvt_pk_bf16_f32 v10, v28, v29
    v_cvt_pk_bf16_f32 v11, v30, v31
    ds_write_b128 v1, v[4:7]
    ds_write_b128 v1, v[8:11] offset:1024
    v_mov_b32 v125, s60
    s_mov_b64 exec, 1
    ds_write_b32 v126, v125
    s_mov_b64 exec, -1
    s_setprio 1
    v_add_u32 v1, 4224, v1
    s_add_u32 s60, s60, 1
    s_cmp_eq_u32 s60, 1
    s_cbranch_scc1 L_lntop
    s_cmp_eq_u32 s60, 2
    s_cbranch_scc1 L_lnloop
    s_branch L_Mmain
L_A:
    s_lshr_b32 s61, s4, 6
    s_bfe_u32 s60, s4, 0x10005
    s_bfe_u32 s62, s4, 0x20004
    s_lshl3_add_u32 s6, s61, s62
    s_lshl_b32 s6, s6, 12
    s_and_b32 s7, s4, 15
    s_lshl2_add_u32 s7, s7, s5
    s_lshl_b32 s7, s7, 6
    s_add_u32 s6, s6, s7
    s_add_u32 s63, s6, 65536
    s_lshl_b32 s62, s62, 9
    s_add_u32 s62, s62, 4608
    s_lshl_b32 s96, 0x10001, s60
    s_xor_b32 s97, s96, 0x30003
    v_and_b32 v5, 1, v0
    v_lshlrev_b32 v5, 14, v5
    v_and_or_b32 v5, v0, 48, v5
    s_waitcnt lgkmcnt(0)
    v_lshrrev_b32 v1, 2, v0
    v_bfe_u32 v2, v0, 3, 2
    v_xor_b32 v2, s5, v2
    v_lshlrev_b32 v2, 5, v2
    v_lshl_add_u32 v2, v1, 7, v2
    v_and_b32 v3, 3, v0
    v_lshl_add_u32 v2, v3, 3, v2
    v_add_u32 v2, 24576, v2
    v_and_b32 v6, 1, v0
    v_mul_u32_u24 v3, 2112, v6
    v_lshrrev_b32 v7, 4, v0
    v_and_b32 v1, 1, v7
    v_lshl_add_u32 v3, v1, 3, v3
    v_lshrrev_b32 v1, 1, v7
    v_lshl_add_u32 v3, v1, 6, v3
    v_add_u32 v3, s62, v3
    s_setprio 2
L_w_7:
    ds_read_b32 v120, v127 offset:40
    ds_read_b32 v114, v127 offset:72
    s_sub_u32 s58, s58, 1
    s_cbranch_scc1 L_end
    s_waitcnt lgkmcnt(1)
    v_cmp_gt_u32 vcc, 1, v120
    s_cbranch_vccnz L_w_7
    s_setprio 2
L_w_8:
    ds_read_b64 v[120:121], v127 offset:32
    s_sub_u32 s58, s58, 1
    s_cbranch_scc1 L_end
    s_waitcnt lgkmcnt(0)
    v_min_u32 v120, v120, v121
    v_cmp_gt_u32 vcc, 1, v120
    s_cbranch_vccnz L_w_8
    ds_read2_b64 v[16:19], v3 offset0:0 offset1:2
    ds_read2_b64 v[20:23], v3 offset0:4 offset1:6
    ds_read2_b64 v[24:27], v3 offset0:16 offset1:18
    ds_read2_b64 v[28:31], v3 offset0:20 offset1:22
    ds_read2_b64 v[32:35], v3 offset0:32 offset1:34
    ds_read2_b64 v[36:39], v3 offset0:36 offset1:38
    ds_read2_b64 v[40:43], v3 offset0:48 offset1:50
    ds_read2_b64 v[44:47], v3 offset0:52 offset1:54
    v_readfirstlane_b32 s56, v114
    v_mov_b32 v124, 0xffffff00
    s_and_b32 s52, s56, 0xff
    s_bfe_u32 s53, s56, 0x80008
    s_bfe_u32 s54, s56, 0x80010
    s_lshr_b32 s55, s56, 24
    s_setprio 2
L_w_9:
    ds_read_b128 v[120:123], v127 offset:0
    s_sub_u32 s58, s58, 1
    s_cbranch_scc1 L_end
    s_waitcnt lgkmcnt(0)
    v_min3_u32 v120, v120, v121, v122
    v_min_u32 v120, v120, v123
    v_cmp_gt_u32 vcc, 9, v120
    s_cbranch_vccnz L_w_9
    ds_read_b64_tr_b16 v[48:49], v2 offset:0
    ds_read_b64_tr_b16 v[50:51], v2 offset:2048
    ds_read_b64_tr_b16 v[64:65], v2 offset:16384
    ds_read_b64_tr_b16 v[66:67], v2 offset:18432
    ds_read_b64_tr_b16 v[56:57], v2 offset:8192
    ds_read_b64_tr_b16 v[58:59], v2 offset:10240
    ds_read_b64_tr_b16 v[72:73], v2 offset:24576
    ds_read_b64_tr_b16 v[74:75], v2 offset:26624
    ds_read_b64_tr_b16 v[52:53], v2 offset:4096
    ds_read_b64_tr_b16 v[54:55], v2 offset:6144
    ds_read_b64_tr_b16 v[68:69], v2 offset:20480
    ds_read_b64_tr_b16 v[70:71], v2 offset:22528
    ds_read_b64_tr_b16 v[60:61], v2 offset:12288
    ds_read_b64_tr_b16 v[62:63], v2 offset:14336
    ds_read_b64_tr_b16 v[76:77], v2 offset:28672
    ds_read_b64_tr_b16 v[78:79], v2 offset:30720
    s_waitcnt lgkmcnt(14)
    v_mfma_f32_16x16x32_bf16 v[8:11], v[48:51], v[16:19], 0
    s_waitcnt lgkmcnt(12)
    v_mfma_f32_16x16x32_bf16 v[12:15], v[64:67], v[32:35], 0
    s_waitcnt lgkmcnt(10)
    v_mfma_f32_16x16x32_bf16 v[8:11], v[56:59], v[24:27], v[8:11]
    s_waitcnt lgkmcnt(8)
    v_mfma_f32_16x16x32_bf16 v[12:15], v[72:75], v[40:43], v[12:15]
    s_waitcnt lgkmcnt(6)
    v_mfma_f32_16x16x32_bf16 v[8:11], v[52:55], v[20:23], v[8:11]
    s_waitcnt lgkmcnt(4)
    v_mfma_f32_16x16x32_bf16 v[12:15], v[68:71], v[36:39], v[12:15]
    s_waitcnt lgkmcnt(2)
    v_mfma_f32_16x16x32_bf16 v[8:11], v[60:63], v[28:31], v[8:11]
    s_waitcnt lgkmcnt(0)
    v_mfma_f32_16x16x32_bf16 v[12:15], v[76:79], v[44:47], v[12:15]
    v_mov_b32 v125, 1
    s_mov_b64 exec, 1
    ds_write_b32 v126, v125
    s_mov_b64 exec, -1
    s_nop 3
    v_pk_add_f32 v[8:9], v[8:9], v[12:13]
    v_pk_add_f32 v[10:11], v[10:11], v[14:15]
    v_and_or_b32 v8, v8, v124, s52
    v_and_or_b32 v9, v9, v124, s53
    v_and_or_b32 v10, v10, v124, s54
    v_and_or_b32 v11, v11, v124, s55
    s_mov_b32 exec_lo, s97
    s_mov_b32 exec_hi, s97
    buffer_store_dwordx4 v[8:11], v5, s[12:15], s63 offen sc1
    s_mov_b32 exec_lo, s96
    s_mov_b32 exec_hi, s96
    buffer_store_dwordx4 v[8:11], v5, s[12:15], s63 offen
    s_mov_b64 exec, -1
    s_lshl_b32 s7, s5, 1
    v_lshrrev_b32 v1, 2, v0
    v_and_b32 v14, 7, v1
    v_xor_b32 v14, s7, v14
    v_lshlrev_b32 v14, 5, v14
    v_lshl_add_u32 v14, v1, 8, v14
    v_and_b32 v1, 3, v0
    v_lshl_add_u32 v14, v1, 3, v14
    v_add_u32 v14, 90112, v14
    v_xor_b32 v15, 32, v14
    v_lshlrev_b32 v1, 4, v0
    s_lshr_b32 s59, s4, 5
    s_lshl4_add_u32 s6, s59, s5
    s_lshl_b32 s6, s6, 10
    s_add_u32 s6, s6, 65536
    v_add_u32 v2, s6, v1
    v_lshrrev_b32 v3, 5, v0
    v_add_u32 v3, s7, v3
    v_mul_u32_u24 v3, 272, v3
    v_and_b32 v4, 31, v0
    v_lshl_add_u32 v3, v4, 3, v3
    v_and_b32 v4, 7, v0
    v_lshrrev_b32 v5, 4, v0
    v_mul_u32_u24 v6, 272, v4
    v_lshl_add_u32 v6, v5, 4, v6
    v_lshlrev_b32 v7, 1, v4
    v_xor_b32 v7, v7, v5
    v_lshlrev_b32 v7, 4, v7
    v_and_b32 v8, 15, v0
    v_lshl_add_u32 v7, v8, 8, v7
    s_lshl_b32 s6, s5, 13
    s_add_u32 s6, s6, 57344
    v_add_u32 v8, s6, v7
    v_xor_b32 v9, 64, v8
    v_xor_b32 v10, 0x80, v8
    v_xor_b32 v11, 0xc0, v8
    v_lshlrev_b32 v12, 14, v4
    v_and_b32 v13, 8, v0
    v_lshl_add_u32 v12, v13, 3, v12
    v_lshl_add_u32 v12, v5, 4, v12
    v_cmp_eq_u32 s[98:99], 8, v13
    v_lshlrev_b32 v13, 3, v5
    s_lshl_b32 s7, s5, 10
    v_add_u32 v116, s7, v1
    s_lshl_b32 s7, s5, 2
    s_add_u32 s7, s7, 21504
    v_add_u32 v117, s7, v1
    s_lshl_b32 s6, s59, 5
    s_add_u32 s6, s6, s5
    s_lshl_b32 s6, s6, 5
    s_and_b32 s7, s4, 31
    s_add_u32 s6, s6, s7
    s_lshl_b32 s6, s6, 7
    s_add_u32 s63, s6, 1048576
    s_getreg_b32 s6, hwreg(HW_REG_XCC_ID, 0, 4)
    s_and_b32 s51, s54, 0xf0
    s_or_b32 s51, s51, s6
    s_mov_b32 s57, 0x3e0293ee
    s_movk_i32 s48, 0x1000
    s_movk_i32 s49, 0x2000
    s_movk_i32 s50, 0x3000
    s_and_b32 s6, s4, 7
    s_cmp_eq_u32 s6, 3
    s_cselect_b32 s47, 16, 19
    s_setprio 2
L_w_10:
    ds_read_b128 v[120:123], v127 offset:0
    s_sub_u32 s58, s58, 1
    s_cbranch_scc1 L_end
    s_waitcnt lgkmcnt(0)
    v_min3_u32 v120, v120, v121, v122
    v_min_u32 v120, v120, v123
    v_cmp_gt_u32 vcc, s47, v120
    s_cbranch_vccnz L_w_10
    buffer_load_dwordx4 v[80:83], v2, s[12:15], 0 offen sc1
    buffer_load_dwordx4 v[84:87], v2, s[12:15], s48 offen sc1
    buffer_load_dwordx4 v[88:91], v2, s[12:15], s49 offen sc1
    buffer_load_dwordx4 v[92:95], v2, s[12:15], s50 offen sc1
    s_setprio 2
L_w_14:
    ds_read_b128 v[120:123], v127 offset:0
    s_sub_u32 s58, s58, 1
    s_cbranch_scc1 L_end
    s_waitcnt lgkmcnt(0)
    v_min3_u32 v120, v120, v121, v122
    v_min_u32 v120, v120, v123
    v_cmp_gt_u32 vcc, 17, v120
    s_cbranch_vccnz L_w_14
    ds_read_b128 v[48:51], v8 offset:0
    ds_read_b128 v[52:55], v9 offset:0
    ds_read_b128 v[56:59], v10 offset:0
    ds_read_b128 v[60:63], v11 offset:0
    ds_read_b128 v[64:67], v8 offset:4096
    ds_read_b128 v[68:71], v9 offset:4096
    ds_read_b128 v[72:75], v10 offset:4096
    ds_read_b128 v[76:79], v11 offset:4096
    s_branch L_g_13
L_g_11:
    s_sub_u32 s58, s58, 16
    s_cmp_lt_i32 s58, 1047376
    s_cbranch_scc1 L_slow_15
L_bk_16:
L_g_13i:
    buffer_load_dwordx4 v[80:83], v2, s[12:15], 0 offen sc1
    buffer_load_dwordx4 v[84:87], v2, s[12:15], s48 offen sc1
    buffer_load_dwordx4 v[88:91], v2, s[12:15], s49 offen sc1
    buffer_load_dwordx4 v[92:95], v2, s[12:15], s50 offen sc1
L_g_13:
    s_waitcnt vmcnt(3)
    v_xor_b32 v32, s52, v80
    v_xor_b32 v33, s53, v81
    v_xor_b32 v34, s54, v82
    v_xor_b32 v35, s55, v83
    v_or3_b32 v112, v32, v33, v34
    v_or_b32 v112, v112, v35
    s_waitcnt vmcnt(2)
    v_xor_b32 v84, s52, v84
    v_xor_b32 v85, s53, v85
    v_xor_b32 v86, s54, v86
    v_xor_b32 v87, s55, v87
    v_or3_b32 v112, v112, v84, v85
    v_or3_b32 v112, v112, v86, v87
    v_pk_add_f32 v[32:33], v[32:33], v[84:85]
    v_pk_add_f32 v[34:35], v[34:35], v[86:87]
    s_waitcnt vmcnt(1)
    v_xor_b32 v88, s52, v88
    v_xor_b32 v89, s53, v89
    v_xor_b32 v90, s54, v90
    v_xor_b32 v91, s55, v91
    v_or3_b32 v112, v112, v88, v89
    v_or3_b32 v112, v112, v90, v91
    v_pk_add_f32 v[32:33], v[32:33], v[88:89]
    v_pk_add_f32 v[34:35], v[34:35], v[90:91]
    s_waitcnt vmcnt(0)
    v_xor_b32 v92, s52, v92
    v_xor_b32 v93, s53, v93
    v_xor_b32 v94, s54, v94
    v_xor_b32 v95, s55, v95
    v_or3_b32 v112, v112, v92, v93
    v_or3_b32 v112, v112, v94, v95
    v_pk_add_f32 v[32:33], v[32:33], v[92:93]
    v_pk_add_f32 v[34:35], v[34:35], v[94:95]
    v_cmp_ne_u32_sdwa vcc, v112, v127 src0_sel:BYTE_0 src1_sel:DWORD
    s_cbranch_vccnz L_g_11
    v_cvt_pk_bf16_f32 v32, v32, v33
    v_cvt_pk_bf16_f32 v33, v34, v35
    ds_write_b64 v3, v[32:33] offset:2304
    v_mov_b32 v125, 2
    s_mov_b64 exec, 1
    ds_write_b32 v126, v125
    s_mov_b64 exec, -1
    s_setprio 2
L_w_17:
    ds_read_b128 v[120:123], v127 offset:16
    ds_read_b128 v[16:19], v6 offset:2304
    ds_read_b128 v[20:23], v6 offset:2368
    ds_read_b128 v[24:27], v6 offset:2432
    ds_read_b128 v[28:31], v6 offset:2496
    ds_read_b128 v[44:47], v127 offset:0
    s_sub_u32 s58, s58, 1
    s_cbranch_scc1 L_end
    s_waitcnt lgkmcnt(5)
    v_min3_u32 v120, v120, v121, v122
    v_min_u32 v120, v120, v123
    v_cmp_gt_u32 vcc, 2, v120
    s_cbranch_vccnz L_w_17
    s_waitcnt lgkmcnt(0)
    v_mfma_f32_16x16x32_bf16 v[32:35], v[48:51], v[16:19], 0
    ds_read_b64_tr_b16 v[80:81], v14 offset:0
    ds_read_b64_tr_b16 v[82:83], v14 offset:4096
    v_mfma_f32_16x16x32_bf16 v[36:39], v[64:67], v[16:19], 0
    ds_read_b64_tr_b16 v[84:85], v15 offset:0
    ds_read_b64_tr_b16 v[86:87], v15 offset:4096
    v_mfma_f32_16x16x32_bf16 v[32:35], v[52:55], v[20:23], v[32:35]
    ds_read_b64_tr_b16 v[88:89], v14 offset:8192
    ds_read_b64_tr_b16 v[90:91], v14 offset:12288
    v_mfma_f32_16x16x32_bf16 v[36:39], v[68:71], v[20:23], v[36:39]
    ds_read_b64_tr_b16 v[92:93], v15 offset:8192
    ds_read_b64_tr_b16 v[94:95], v15 offset:12288
    v_mfma_f32_16x16x32_bf16 v[32:35], v[56:59], v[24:27], v[32:35]
    ds_read_b64_tr_b16 v[96:97], v14 offset:16384
    ds_read_b64_tr_b16 v[98:99], v14 offset:20480
    v_mfma_f32_16x16x32_bf16 v[36:39], v[72:75], v[24:27], v[36:39]
    ds_read_b64_tr_b16 v[100:101], v15 offset:16384
    ds_read_b64_tr_b16 v[102:103], v15 offset:20480
    v_mfma_f32_16x16x32_bf16 v[32:35], v[60:63], v[28:31], v[32:35]
    ds_read_b64_tr_b16 v[104:105], v14 offset:24576
    ds_read_b64_tr_b16 v[106:107], v14 offset:28672
    v_mfma_f32_16x16x32_bf16 v[36:39], v[76:79], v[28:31], v[36:39]
    ds_read_b64_tr_b16 v[108:109], v15 offset:24576
    ds_read_b64_tr_b16 v[110:111], v15 offset:28672
    v_min3_u32 v44, v44, v45, v46
    v_min_u32 v44, v44, v47
    v_cmp_gt_u32 vcc, 25, v44
    v_max3_f32 v40, v32, v33, v34
    s_nop 1
    v_max3_f32 v41, v35, v36, v37
    v_max3_f32 v40, v40, v38, v39
    v_max_f32 v40, v40, v41
    v_mov_b32 v41, v40
    s_nop 1
    v_permlane32_swap_b32 v40, v41
    v_max_f32 v40, v40, v41
    v_mov_b32 v41, v40
    s_nop 1
    v_permlane16_swap_b32 v40, v41
    v_max_f32 v40, v40, v41
    v_mul_f32 v40, s57, v40
    v_fma_f32 v32, v32, s57, -v40
    v_fma_f32 v33, v33, s57, -v40
    v_fma_f32 v34, v34, s57, -v40
    v_fma_f32 v35, v35, s57, -v40
    v_fma_f32 v36, v36, s57, -v40
    v_fma_f32 v37, v37, s57, -v40
    v_fma_f32 v38, v38, s57, -v40
    v_fma_f32 v39, v39, s57, -v40
    v_exp_f32 v32, v32
    v_exp_f32 v33, v33
    v_exp_f32 v34, v34
    v_exp_f32 v35, v35
    v_exp_f32 v36, v36
    v_exp_f32 v37, v37
    v_exp_f32 v38, v38
    v_exp_f32 v39, v39
    v_cvt_pk_bf16_f32 v8, v32, v33
    v_cvt_pk_bf16_f32 v9, v34, v35
    v_cvt_pk_bf16_f32 v10, v36, v37
    v_cvt_pk_bf16_f32 v11, v38, v39
    v_pk_add_f32 v[32:33], v[32:33], v[34:35]
    v_pk_add_f32 v[36:37], v[36:37], v[38:39]
    ds_write_b128 v116, v[8:11] offset:13056
    v_pk_add_f32 v[32:33], v[32:33], v[36:37]
    v_add_f32 v41, v32, v33
    ds_write2st64_b32 v117, v40, v41 offset0:0 offset1:4
    v_mov_b32 v125, 3
    s_mov_b64 exec, 1
    ds_write_b32 v126, v125
    s_mov_b64 exec, -1
    s_cbranch_vccz L_vok
    s_setprio 2
L_w_18:
    ds_read_b128 v[120:123], v127 offset:16
    ds_read_b128 v[16:19], v1 offset:13056
    ds_read_b128 v[20:23], v1 offset:14080
    ds_read_b128 v[24:27], v1 offset:15104
    ds_read_b128 v[28:31], v1 offset:16128
    ds_read_b128 v[40:43], v1 offset:21504
    ds_read_b128 v[44:47], v1 offset:22528
    s_sub_u32 s58, s58, 1
    s_cbranch_scc1 L_end
    s_waitcnt lgkmcnt(6)
    v_min3_u32 v120, v120, v121, v122
    v_min_u32 v120, v120, v123
    v_cmp_gt_u32 vcc, 3, v120
    s_cbranch_vccnz L_w_18
    s_waitcnt lgkmcnt(0)
    v_max3_f32 v36, v40, v41, v42
    v_max_f32 v36, v36, v43
    v_pk_add_f32 v[40:41], v[40:41], v[36:37] op_sel_hi:[1,0] neg_lo:[0,1] neg_hi:[0,1]
    v_pk_add_f32 v[42:43], v[42:43], v[36:37] op_sel_hi:[1,0] neg_lo:[0,1] neg_hi:[0,1]
    v_exp_f32 v40, v40
    v_exp_f32 v41, v41
    v_exp_f32 v42, v42
    v_exp_f32 v43, v43
    v_pk_mul_f32 v[44:45], v[44:45], v[40:41]
    v_pk_fma_f32 v[44:45], v[46:47], v[42:43], v[44:45]
    v_add_f32 v37, v44, v45
    v_mov_b32 v38, v37
    s_setprio 2
L_w_19:
    ds_read_b128 v[120:123], v127 offset:0
    s_sub_u32 s58, s58, 1
    s_cbranch_scc1 L_end
    s_waitcnt lgkmcnt(0)
    v_min3_u32 v120, v120, v121, v122
    v_min_u32 v120, v120, v123
    v_cmp_gt_u32 vcc, 25, v120
    s_cbranch_vccnz L_w_19
    ds_read_b64_tr_b16 v[80:81], v14 offset:0
    ds_read_b64_tr_b16 v[82:83], v14 offset:4096
    ds_read_b64_tr_b16 v[84:85], v15 offset:0
    ds_read_b64_tr_b16 v[86:87], v15 offset:4096
    ds_read_b64_tr_b16 v[88:89], v14 offset:8192
    ds_read_b64_tr_b16 v[90:91], v14 offset:12288
    ds_read_b64_tr_b16 v[92:93], v15 offset:8192
    ds_read_b64_tr_b16 v[94:95], v15 offset:12288
    ds_read_b64_tr_b16 v[96:97], v14 offset:16384
    ds_read_b64_tr_b16 v[98:99], v14 offset:20480
    ds_read_b64_tr_b16 v[100:101], v15 offset:16384
    ds_read_b64_tr_b16 v[102:103], v15 offset:20480
    ds_read_b64_tr_b16 v[104:105], v14 offset:24576
    ds_read_b64_tr_b16 v[106:107], v14 offset:28672
    ds_read_b64_tr_b16 v[108:109], v15 offset:24576
    ds_read_b64_tr_b16 v[110:111], v15 offset:28672
    s_waitcnt lgkmcnt(14)
    v_mfma_f32_16x16x32_bf16 v[48:51], v[80:83], v[16:19], 0
    s_waitcnt lgkmcnt(12)
    v_mfma_f32_16x16x32_bf16 v[52:55], v[84:87], v[16:19], 0
    s_waitcnt lgkmcnt(10)
    v_mfma_f32_16x16x32_bf16 v[56:59], v[88:91], v[20:23], 0
    s_waitcnt lgkmcnt(8)
    v_mfma_f32_16x16x32_bf16 v[60:63], v[92:95], v[20:23], 0
    s_waitcnt lgkmcnt(6)
    v_mfma_f32_16x16x32_bf16 v[64:67], v[96:99], v[24:27], 0
    s_waitcnt lgkmcnt(4)
    v_mfma_f32_16x16x32_bf16 v[68:71], v[100:103], v[24:27], 0
    s_waitcnt lgkmcnt(2)
    v_mfma_f32_16x16x32_bf16 v[72:75], v[104:107], v[28:31], 0
    s_waitcnt lgkmcnt(0)
    v_mfma_f32_16x16x32_bf16 v[76:79], v[108:111], v[28:31], 0
    s_branch L_vcomb
L_vok:
    s_setprio 2
L_w_20:
    ds_read_b128 v[120:123], v127 offset:16
    ds_read_b128 v[16:19], v1 offset:13056
    ds_read_b128 v[20:23], v1 offset:14080
    ds_read_b128 v[24:27], v1 offset:15104
    ds_read_b128 v[28:31], v1 offset:16128
    ds_read_b128 v[40:43], v1 offset:21504
    ds_read_b128 v[44:47], v1 offset:22528
    s_sub_u32 s58, s58, 1
    s_cbranch_scc1 L_end
    s_waitcnt lgkmcnt(6)
    v_min3_u32 v120, v120, v121, v122
    v_min_u32 v120, v120, v123
    v_cmp_gt_u32 vcc, 3, v120
    s_cbranch_vccnz L_w_20
    s_waitcnt lgkmcnt(5)
    v_mfma_f32_16x16x32_bf16 v[48:51], v[80:83], v[16:19], 0
    v_mfma_f32_16x16x32_bf16 v[52:55], v[84:87], v[16:19], 0
    s_waitcnt lgkmcnt(0)
    v_mfma_f32_16x16x32_bf16 v[56:59], v[88:91], v[20:23], 0
    v_max3_f32 v36, v40, v41, v42
    v_max_f32 v36, v36, v43
    v_mfma_f32_16x16x32_bf16 v[60:63], v[92:95], v[20:23], 0
    v_pk_add_f32 v[40:41], v[40:41], v[36:37] op_sel_hi:[1,0] neg_lo:[0,1] neg_hi:[0,1]
    v_pk_add_f32 v[42:43], v[42:43], v[36:37] op_sel_hi:[1,0] neg_lo:[0,1] neg_hi:[0,1]
    v_mfma_f32_16x16x32_bf16 v[64:67], v[96:99], v[24:27], 0
    v_exp_f32 v40, v40
    v_exp_f32 v41, v41
    v_mfma_f32_16x16x32_bf16 v[68:71], v[100:103], v[24:27], 0
    v_exp_f32 v42, v42
    v_exp_f32 v43, v43
    v_mfma_f32_16x16x32_bf16 v[72:75], v[104:107], v[28:31], 0
    v_pk_mul_f32 v[44:45], v[44:45], v[40:41]
    v_pk_fma_f32 v[44:45], v[46:47], v[42:43], v[44:45]
    v_mfma_f32_16x16x32_bf16 v[76:79], v[108:111], v[28:31], 0
    v_add_f32 v37, v44, v45
    v_mov_b32 v38, v37
L_vcomb:
    v_cndmask_b32 v48, v48, v52, s[98:99]
    v_cndmask_b32 v49, v49, v53, s[98:99]
    v_cndmask_b32 v50, v50, v54, s[98:99]
    v_cndmask_b32 v51, v51, v55, s[98:99]
    v_permlane32_swap_b32 v37, v38
    v_add_f32 v37, v37, v38
    v_mov_b32 v38, v37
    v_pk_mul_f32 v[32:33], v[48:49], v[40:41] op_sel:[0,0] op_sel_hi:[1,0]
    v_pk_mul_f32 v[34:35], v[50:51], v[40:41] op_sel:[0,0] op_sel_hi:[1,0]
    v_cndmask_b32 v56, v56, v60, s[98:99]
    v_cndmask_b32 v57, v57, v61, s[98:99]
    v_cndmask_b32 v58, v58, v62, s[98:99]
    v_cndmask_b32 v59, v59, v63, s[98:99]
    v_permlane16_swap_b32 v37, v38
    v_add_f32 v37, v37, v38
    v_pk_fma_f32 v[32:33], v[56:57], v[40:41], v[32:33] op_sel:[0,1,0] op_sel_hi:[1,1,1]
    v_pk_fma_f32 v[34:35], v[58:59], v[40:41], v[34:35] op_sel:[0,1,0] op_sel_hi:[1,1,1]
    v_cndmask_b32 v64, v64, v68, s[98:99]
    v_cndmask_b32 v65, v65, v69, s[98:99]
    v_cndmask_b32 v66, v66, v70, s[98:99]
    v_cndmask_b32 v67, v67, v71, s[98:99]
    v_rcp_f32 v38, v37
    v_log_f32 v37, v37
    v_pk_fma_f32 v[32:33], v[64:65], v[42:43], v[32:33] op_sel:[0,0,0] op_sel_hi:[1,0,1]
    v_pk_fma_f32 v[34:35], v[66:67], v[42:43], v[34:35] op_sel:[0,0,0] op_sel_hi:[1,0,1]
    v_cndmask_b32 v72, v72, v76, s[98:99]
    v_cndmask_b32 v73, v73, v77, s[98:99]
    v_cndmask_b32 v74, v74, v78, s[98:99]
    v_cndmask_b32 v75, v75, v79, s[98:99]
    v_add_f32 v36, v36, v37
    v_bfe_u32 v36, v36, v13, 8
    v_pk_fma_f32 v[32:33], v[72:73], v[42:43], v[32:33] op_sel:[0,1,0] op_sel_hi:[1,1,1]
    v_pk_fma_f32 v[34:35], v[74:75], v[42:43], v[34:35] op_sel:[0,1,0] op_sel_hi:[1,1,1]
    v_pk_mul_f32 v[32:33], v[32:33], v[38:39] op_sel_hi:[1,0]
    v_pk_mul_f32 v[34:35], v[34:35], v[38:39] op_sel_hi:[1,0]
    v_and_or_b32 v32, v32, v124, s52
    v_and_or_b32 v33, v33, v124, s53
    v_and_or_b32 v34, v34, v124, s51
    v_and_or_b32 v35, v35, v124, v36
    buffer_store_dwordx4 v[32:35], v12, s[12:15], s63 offen
    s_cmp_ge_u32 s5, 2
    s_cbranch_scc1 L_final
    s_cmp_eq_u32 s5, 1
    s_cbranch_scc1 L_fin
    s_lshl_b32 s6, s4, 12
    s_add_u32 s96, s6, 1048576
    s_bfe_u32 s6, s4, 0x30002
    s_lshl3_add_u32 s6, s61, s6
    s_lshl1_add_u32 s6, s6, s60
    s_and_b32 s7, s4, 3
    s_lshl2_add_u32 s6, s6, s7
    s_lshl_b32 s6, s6, 7
    s_add_u32 s40, s6, 786432
    s_and_b32 s48, s56, 0xffff
    v_lshl_add_u32 v3, v4, 2, v5
    s_and_b32 s6, s4, 7
    v_xor_b32 v3, s6, v3
    v_lshlrev_b32 v3, 2, v3
    v_and_b32 v7, 8, v0
    v_lshl_add_u32 v3, v7, 12, v3
    v_and_b32 v2, 3, v0
    v_lshlrev_b32 v2, 3, v2
    v_mov_b32 v6, 12
    v_lshlrev_b32 v2, v2, v6
    v_xor_b32 v2, 0x0c0c0c0c, v2
    v_mov_b32 v6, 0xffff0000
    s_branch L_g_23i
L_g_21:
    s_sub_u32 s58, s58, 16
    s_cmp_lt_i32 s58, 1047376
    s_cbranch_scc1 L_slow_24
L_bk_25:
L_g_23i:
    buffer_load_dwordx4 v[48:51], v1, s[12:15], s96 offen offset:0 sc1
    buffer_load_dwordx4 v[52:55], v1, s[12:15], s96 offen offset:1024 sc1
    buffer_load_dwordx4 v[56:59], v1, s[12:15], s96 offen offset:2048 sc1
    buffer_load_dwordx4 v[60:63], v1, s[12:15], s96 offen offset:3072 sc1
L_g_23:
    s_waitcnt vmcnt(3)
    v_perm_b32 v40, v51, v51, v2
    v_xor_b32 v16, s52, v48
    v_xor_b32 v17, s53, v49
    v_xor_b32 v48, s51, v50
    v_or_b32_dpp v40, v40, v40 quad_perm:[1,0,3,2] row_mask:0xf bank_mask:0xf
    v_and_b32 v18, v124, v50
    v_and_b32 v19, v124, v51
    v_or_b32 v32, v16, v17
    v_or_b32_dpp v40, v40, v40 quad_perm:[2,3,0,1] row_mask:0xf bank_mask:0xf
    s_waitcnt vmcnt(2)
    v_perm_b32 v41, v55, v55, v2
    v_xor_b32 v20, s52, v52
    v_xor_b32 v21, s53, v53
    v_xor_b32 v52, s51, v54
    v_or_b32_dpp v41, v41, v41 quad_perm:[1,0,3,2] row_mask:0xf bank_mask:0xf
    v_and_b32 v22, v124, v54
    v_and_b32 v23, v124, v55
    v_or3_b32 v32, v32, v20, v21
    v_or_b32_dpp v41, v41, v41 quad_perm:[2,3,0,1] row_mask:0xf bank_mask:0xf
    s_waitcnt vmcnt(1)
    v_perm_b32 v42, v59, v59, v2
    v_xor_b32 v24, s52, v56
    v_xor_b32 v25, s53, v57
    v_xor_b32 v56, s51, v58
    v_or_b32_dpp v42, v42, v42 quad_perm:[1,0,3,2] row_mask:0xf bank_mask:0xf
    v_and_b32 v26, v124, v58
    v_and_b32 v27, v124, v59
    v_or3_b32 v32, v32, v24, v25
    v_or_b32_dpp v42, v42, v42 quad_perm:[2,3,0,1] row_mask:0xf bank_mask:0xf
    s_waitcnt vmcnt(0)
    v_perm_b32 v43, v63, v63, v2
    v_xor_b32 v28, s52, v60
    v_xor_b32 v29, s53, v61
    v_xor_b32 v60, s51, v62
    v_or_b32_dpp v43, v43, v43 quad_perm:[1,0,3,2] row_mask:0xf bank_mask:0xf
    v_and_b32 v30, v124, v62
    v_and_b32 v31, v124, v63
    v_or3_b32 v32, v32, v28, v29
    v_or_b32_dpp v43, v43, v43 quad_perm:[2,3,0,1] row_mask:0xf bank_mask:0xf
    v_or3_b32 v33, v48, v52, v56
    v_max3_f32 v36, v40, v41, v42
    v_or_b32 v33, v33, v60
    v_max_f32 v36, v36, v43
    v_and_or_b32 v32, v33, -16, v32
    v_cmp_ne_u32_sdwa vcc, v32, v127 src0_sel:BYTE_0 src1_sel:DWORD
    s_cbranch_vccnz L_g_21
    v_mov_b32 v37, v36
    s_nop 1
    v_permlane32_swap_b32 v36, v37
    v_max_f32 v36, v36, v37
    v_mov_b32 v37, v36
    s_nop 1
    v_permlane16_swap_b32 v36, v37
    v_max_f32 v36, v36, v37
    s_nop 1
    v_max_f32_dpp v36, v36, v36 row_ror:8 row_mask:0xf bank_mask:0xf
    v_pk_add_f32 v[40:41], v[40:41], v[36:37] op_sel_hi:[1,0] neg_lo:[0,1] neg_hi:[0,1]
    v_pk_add_f32 v[42:43], v[42:43], v[36:37] op_sel_hi:[1,0] neg_lo:[0,1] neg_hi:[0,1]
    v_exp_f32 v40, v40
    v_exp_f32 v41, v41
    v_exp_f32 v42, v42
    v_exp_f32 v43, v43
    v_pk_mul_f32 v[16:17], v[16:17], v[40:41] op_sel_hi:[1,0]
    v_pk_mul_f32 v[18:19], v[18:19], v[40:41] op_sel_hi:[1,0]
    v_pk_add_f32 v[36:37], v[40:41], v[42:43]
    v_pk_fma_f32 v[16:17], v[20:21], v[40:41], v[16:17] op_sel:[0,1,0] op_sel_hi:[1,1,1]
    v_pk_fma_f32 v[18:19], v[22:23], v[40:41], v[18:19] op_sel:[0,1,0] op_sel_hi:[1,1,1]
    v_add_f32 v36, v36, v37
    v_pk_fma_f32 v[16:17], v[24:25], v[42:43], v[16:17] op_sel_hi:[1,0,1]
    v_pk_fma_f32 v[18:19], v[26:27], v[42:43], v[18:19] op_sel_hi:[1,0,1]
    v_mov_b32 v37, v36
    v_pk_fma_f32 v[16:17], v[28:29], v[42:43], v[16:17] op_sel:[0,1,0] op_sel_hi:[1,1,1]
    v_pk_fma_f32 v[18:19], v[30:31], v[42:43], v[18:19] op_sel:[0,1,0] op_sel_hi:[1,1,1]
    v_permlane32_swap_b32 v36, v37
    v_add_f32 v36, v36, v37
    v_permlane32_swap_b32 v16, v18
    v_permlane32_swap_b32 v17, v19
    v_mov_b32 v37, v36
    v_add_f32 v16, v16, v18
    v_add_f32 v17, v17, v19
    v_permlane16_swap_b32 v36, v37
    v_add_f32 v36, v36, v37
    v_permlane16_swap_b32 v16, v17
    v_add_f32 v16, v16, v17
    v_add_f32_dpp v36, v36, v36 row_ror:8 row_mask:0xf bank_mask:0xf
    v_rcp_f32 v36, v36
    v_add_f32_dpp v16, v16, v16 row_ror:8 row_mask:0xf bank_mask:0xf
    v_mul_f32 v16, v16, v36
    v_cvt_pk_bf16_f32 v16, v16, v16
    v_and_or_b32 v17, v16, v6, s48
    s_mov_b32 exec_lo, 0xff00ff
    s_mov_b32 exec_hi, 0xff00ff
    buffer_store_dword v17, v3, s[12:15], s40 offen sc1
    s_mov_b64 exec, -1
    v_cmp_ne_u32_sdwa vcc, v33, v127 src0_sel:BYTE_0 src1_sel:DWORD
    s_nop 0
    s_or_b32 s6, vcc_lo, vcc_hi
    v_mov_b32 v34, s6
    ds_write_b32 v127, v34 offset:76
    v_mov_b32 v125, 3
    s_mov_b64 exec, 1
    ds_write_b32 v127, v125 offset:48
    s_mov_b64 exec, -1
    s_branch L_fin
L_final:
    s_load_dwordx4 s[44:47], s[0:1], 72
    s_lshl2_add_u32 s6, s60, s61
    s_lshl_b32 s6, s6, 5
    s_and_b32 s7, s4, 31
    s_add_u32 s7, s6, s7
    v_and_b32 v3, 1, v0
    v_lshrrev_b32 v2, 1, v0
    v_mul_u32_u24 v2, 8320, v2
    v_lshl_add_u32 v2, v3, 4, v2
    s_lshl_b32 s59, s7, 5
    v_add_u32 v2, s59, v2
    v_lshlrev_b32 v7, 2, v0
    s_lshl_b32 s6, s7, 3
    s_waitcnt lgkmcnt(0)
    s_cmp_eq_u32 s5, 3
    s_cbranch_scc1 L_fins
    s_load_dwordx2 s[48:49], s[44:45], s6
    s_mov_b32 s96, 458752
    v_lshlrev_b32 v6, 4, v5
    s_waitcnt lgkmcnt(0)
    v_lshrrev_b64 v[8:9], v6, s[48:49]
    v_lshlrev_b32 v119, 16, v8
    s_setprio 0
L_w_26:
    ds_read_b128 v[120:123], v127 offset:32
    s_sub_u32 s58, s58, 1
    s_cbranch_scc1 L_end
    s_waitcnt lgkmcnt(0)
    v_min3_u32 v120, v120, v121, v122
    v_min_u32 v120, v120, v123
    v_cmp_gt_u32 vcc, 5, v120
    s_cbranch_vccnz L_w_26
    s_setprio 2
    s_branch L_g_29i
L_g_27:
    s_sub_u32 s58, s58, 16
    s_cmp_lt_i32 s58, 1047376
    s_cbranch_scc1 L_slow_30
L_bk_31:
L_g_29i:
    buffer_load_dwordx4 v[48:51], v2, s[12:15], s96 offen sc1
L_g_29:
    s_waitcnt vmcnt(0)
    v_xor_b32 v16, s52, v48
    v_xor_b32 v17, s53, v49
    v_xor_b32 v18, s54, v50
    v_xor_b32 v19, s55, v51
    v_or3_b32 v32, v16, v17, v18
    v_or_b32 v32, v32, v19
    v_cmp_ne_u32_sdwa vcc, v32, v127 src0_sel:BYTE_0 src1_sel:DWORD
    s_cbranch_vccnz L_g_27
    v_permlane32_swap_b32 v16, v18
    v_permlane32_swap_b32 v17, v19
    v_add_f32 v16, v16, v18
    v_add_f32 v17, v17, v19
    s_nop 1
    v_permlane16_swap_b32 v16, v17
    v_add_f32 v16, v16, v17
    s_nop 1
    v_add_f32_dpp v16, v16, v16 row_ror:8 row_mask:0xf bank_mask:0xf
    s_nop 1
    v_add_f32_dpp v16, v16, v16 row_ror:4 row_mask:0xf bank_mask:0xf
    s_nop 1
    v_add_f32_dpp v16, v16, v16 row_ror:2 row_mask:0xf bank_mask:0xf
    v_cvt_pk_bf16_f32 v16, v16, v16
    v_and_b32 v16, 0xffff0000, v16
    v_add_f32 v16, v16, v119
    v_cvt_pk_bf16_f32 v16, v16, v16
    v_and_b32 v16, 0xffff0000, v16
    v_mul_f32 v17, 0xbfb8aa3b, v16
    v_exp_f32 v17, v17
    s_nop 0
    v_add_f32 v17, 1.0, v17
    v_rcp_f32 v17, v17
    s_nop 0
    v_mul_f32 v40, v16, v17
    v_cvt_pk_bf16_f32 v40, v40, v40
    v_and_b32 v40, 0xffff0000, v40
    ds_write_b32 v7, v40 offset:21248
    v_mov_b32 v125, 1
    s_mov_b64 exec, 1
    ds_write_b32 v127, v125 offset:56
    s_mov_b64 exec, -1
    s_branch L_fin
L_fins:
    s_mov_b64 s[44:45], s[46:47]
    s_movk_i32 s46, 0x1000
    s_mov_b32 s47, 0x20000
    v_lshlrev_b32 v6, 11, v3
    v_lshl_add_u32 v6, v5, 1, v6
    v_add_u32 v6, s6, v6
    ds_read_u16 v118, v6 offset:17152
    buffer_load_ushort v115, v6, s[44:47], 0 offen
    v_lshrrev_b32 v2, 1, v0
    v_and_b32 v8, 7, v2
    v_lshlrev_b32 v8, 7, v8
    s_and_b32 s7, s4, 31
    s_lshl_b32 s7, s7, 5
    v_xor_b32 v8, s7, v8
    v_lshl_add_u32 v2, v2, 12, v8
    v_lshl_add_u32 v2, v3, 4, v2
    s_lshr_b32 s6, s4, 5
    s_lshl_b32 s6, s6, 17
    s_add_u32 s60, s6, 1048576
    s_or_b32 s52, s52, 1
    s_setprio 0
L_w_32:
    ds_read_b32 v120, v127 offset:48
    ds_read_b32 v119, v127 offset:76
    s_sub_u32 s58, s58, 1
    s_cbranch_scc1 L_end
    s_waitcnt lgkmcnt(1)
    v_cmp_gt_u32 vcc, 1, v120
    s_cbranch_vccnz L_w_32
    s_setprio 2
    s_setprio 0
L_w_33:
    ds_read_b128 v[120:123], v127 offset:0
    s_sub_u32 s58, s58, 1
    s_cbranch_scc1 L_end
    s_waitcnt lgkmcnt(0)
    v_min3_u32 v120, v120, v121, v122
    v_min_u32 v120, v120, v123
    v_cmp_gt_u32 vcc, 64, v120
    s_cbranch_vccnz L_w_33
    s_setprio 2
    v_lshlrev_b32 v118, 16, v118
    s_branch L_g_36i
L_g_34:
    s_sub_u32 s58, s58, 16
    s_cmp_lt_i32 s58, 1047376
    s_cbranch_scc1 L_slow_37
L_bk_38:
L_g_36i:
    buffer_load_dwordx4 v[48:51], v2, s[12:15], s60 offen sc1
L_g_36:
    s_waitcnt vmcnt(0)
    v_xor_b32 v16, s52, v48
    v_xor_b32 v17, s53, v49
    v_xor_b32 v18, s54, v50
    v_xor_b32 v19, s55, v51
    v_or3_b32 v32, v16, v17, v18
    v_or_b32 v32, v32, v19
    v_cmp_ne_u32_sdwa vcc, v32, v127 src0_sel:BYTE_0 src1_sel:DWORD
    s_cbranch_vccnz L_g_34
    ds_read_b32 v41, v127 offset:56
    ds_read_b32 v40, v7 offset:21248
    v_permlane32_swap_b32 v16, v18
    v_permlane32_swap_b32 v17, v19
    v_add_f32 v16, v16, v18
    v_add_f32 v17, v17, v19
    s_nop 1
    v_permlane16_swap_b32 v16, v17
    v_add_f32 v16, v16, v17
    s_nop 1
    v_add_f32_dpp v16, v16, v16 row_ror:8 row_mask:0xf bank_mask:0xf
    s_nop 1
    v_add_f32_dpp v16, v16, v16 row_ror:4 row_mask:0xf bank_mask:0xf
    s_nop 1
    v_add_f32_dpp v16, v16, v16 row_ror:2 row_mask:0xf bank_mask:0xf
    v_cvt_pk_bf16_f32 v16, v16, v16
    v_and_b32 v16, 0xffff0000, v16
    s_branch L_gw_39b
L_gw_39:
    ds_read_b32 v41, v127 offset:56
    ds_read_b32 v40, v7 offset:21248
    s_sub_u32 s58, s58, 1
    s_cbranch_scc1 L_end
L_gw_39b:
    s_waitcnt lgkmcnt(0)
    v_cmp_gt_u32 vcc, 1, v41
    s_cbranch_vccnz L_gw_39
    v_mul_f32 v16, v16, v40
    v_cvt_pk_bf16_f32 v16, v16, v16
    v_and_b32 v16, 0xffff0000, v16
    v_cmp_ne_u32 vcc, 0, v119
    v_add_f32 v16, v16, v118
    v_cvt_pk_bf16_f32 v16, v16, v16
    s_mov_b32 exec_lo, 0x30003
    s_mov_b32 exec_hi, 0x30003
    buffer_store_short v16, v6, s[44:47], 0 offen
    s_cmp_eq_u32 s4, 0
    s_cbranch_scc0 L_fin2
    s_mov_b64 exec, 1
    v_mov_b32 v17, s56
    buffer_store_dword v17, v127, s[12:15], 0 offen sc1
    s_branch L_fin2
L_Mmain:
    s_waitcnt vmcnt(0) lgkmcnt(0)
    s_load_dwordx2 s[40:41], s[0:1], 56
    s_movk_i32 s42, 7168
    s_mov_b32 s43, 0x20000
    s_lshr_b32 s6, s4, 5
    s_add_u32 s6, s6, 3
    s_and_b32 s6, s6, 7
    s_min_u32 s6, s6, 6
    s_and_b32 s7, s4, 7
    s_lshr_b32 s59, s7, 2
    s_sub_u32 s59, s7, s59
    s_bfe_u32 s60, s4, 0x20003
    s_lshl_b32 s60, s60, 1
    s_cmp_eq_u32 s7, 3
    s_cselect_b32 s59, s6, s59
    s_addc_u32 s60, s60, 0
    s_cmp_eq_u32 s59, s6
    s_cselect_b32 s61, 1, 0
    s_lshr_b32 s62, s4, 5
    s_mul_i32 s97, s62, 28672
    s_add_u32 s97, s97, 196608
    s_mul_i32 s63, s60, 3584
    s_add_u32 s63, s63, s97
    s_lshl2_add_u32 s6, s59, s5
    s_lshl_b32 s6, s6, 6
    s_add_u32 s63, s63, s6
    s_lshl_b32 s60, s60, 8
    s_add_u32 s60, s60, 8832
    s_cmp_eq_u32 s61, 1
    s_cselect_b32 s96, 0x30003, -1
    s_and_b32 s96, s96, 0xf000f
    v_and_b32 v5, 3, v0
    v_mul_u32_u24 v5, 1792, v5
    v_and_or_b32 v5, v0, 48, v5
    v_and_b32 v4, 2, v0
    v_cmp_eq_u32 s[98:99], 2, v4
    s_waitcnt lgkmcnt(0)
    v_lshrrev_b32 v1, 2, v0
    v_bfe_u32 v2, v0, 3, 2
    v_xor_b32 v2, s5, v2
    v_lshlrev_b32 v2, 5, v2
    v_lshl_add_u32 v2, v1, 7, v2
    v_and_b32 v3, 3, v0
    v_lshl_add_u32 v2, v3, 3, v2
    v_add_u32 v2, 122880, v2
    v_and_b32 v6, 1, v0
    v_mul_u32_u24 v3, 2112, v6
    v_lshrrev_b32 v7, 4, v0
    v_lshl_add_u32 v3, v7, 3, v3
    v_add_u32 v3, s60, v3
    s_setprio 2
L_w_40:
    ds_read_b32 v120, v127 offset:40
    ds_read_b32 v114, v127 offset:72
    s_sub_u32 s58, s58, 1
    s_cbranch_scc1 L_end
    s_waitcnt lgkmcnt(1)
    v_cmp_gt_u32 vcc, 1, v120
    s_cbranch_vccnz L_w_40
    s_setprio 2
L_w_41:
    ds_read_b64 v[120:121], v127 offset:32
    s_sub_u32 s58, s58, 1
    s_cbranch_scc1 L_end
    s_waitcnt lgkmcnt(0)
    v_min_u32 v120, v120, v121
    v_cmp_gt_u32 vcc, 2, v120
    s_cbranch_vccnz L_w_41
    ds_read2_b64 v[16:19], v3 offset0:0 offset1:4
    ds_read2_b64 v[20:23], v3 offset0:8 offset1:12
    ds_read2_b64 v[24:27], v3 offset0:16 offset1:20
    ds_read2_b64 v[28:31], v3 offset0:24 offset1:28
    ds_read2_b64 v[32:35], v3 offset0:32 offset1:36
    ds_read2_b64 v[36:39], v3 offset0:40 offset1:44
    ds_read2_b64 v[40:43], v3 offset0:48 offset1:52
    ds_read2_b64 v[44:47], v3 offset0:56 offset1:60
    v_readfirstlane_b32 s56, v114
    v_mov_b32 v124, 0xffffff00
    s_and_b32 s52, s56, 0xff
    s_bfe_u32 s53, s56, 0x80008
    s_bfe_u32 s54, s56, 0x80010
    s_lshr_b32 s55, s56, 24
    s_setprio 2
L_w_42:
    ds_read_b128 v[120:123], v127 offset:0
    s_sub_u32 s58, s58, 1
    s_cbranch_scc1 L_end
    s_waitcnt lgkmcnt(0)
    v_min3_u32 v120, v120, v121, v122
    v_min_u32 v120, v120, v123
    v_cmp_gt_u32 vcc, 33, v120
    s_cbranch_vccnz L_w_42
    ds_read_b64_tr_b16 v[48:49], v2 offset:0
    ds_read_b64_tr_b16 v[50:51], v2 offset:2048
    ds_read_b64_tr_b16 v[64:65], v2 offset:16384
    ds_read_b64_tr_b16 v[66:67], v2 offset:18432
    ds_read_b64_tr_b16 v[56:57], v2 offset:8192
    ds_read_b64_tr_b16 v[58:59], v2 offset:10240
    ds_read_b64_tr_b16 v[72:73], v2 offset:24576
    ds_read_b64_tr_b16 v[74:75], v2 offset:26624
    ds_read_b64_tr_b16 v[52:53], v2 offset:4096
    ds_read_b64_tr_b16 v[54:55], v2 offset:6144
    ds_read_b64_tr_b16 v[68:69], v2 offset:20480
    ds_read_b64_tr_b16 v[70:71], v2 offset:22528
    ds_read_b64_tr_b16 v[60:61], v2 offset:12288
    ds_read_b64_tr_b16 v[62:63], v2 offset:14336
    ds_read_b64_tr_b16 v[76:77], v2 offset:28672
    ds_read_b64_tr_b16 v[78:79], v2 offset:30720
    s_waitcnt lgkmcnt(14)
    v_mfma_f32_16x16x32_bf16 v[8:11], v[48:51], v[16:19], 0
    s_waitcnt lgkmcnt(12)
    v_mfma_f32_16x16x32_bf16 v[12:15], v[64:67], v[32:35], 0
    s_waitcnt lgkmcnt(10)
    v_mfma_f32_16x16x32_bf16 v[8:11], v[56:59], v[24:27], v[8:11]
    s_waitcnt lgkmcnt(8)
    v_mfma_f32_16x16x32_bf16 v[12:15], v[72:75], v[40:43], v[12:15]
    s_waitcnt lgkmcnt(6)
    v_mfma_f32_16x16x32_bf16 v[8:11], v[52:55], v[20:23], v[8:11]
    s_waitcnt lgkmcnt(4)
    v_mfma_f32_16x16x32_bf16 v[12:15], v[68:71], v[36:39], v[12:15]
    s_waitcnt lgkmcnt(2)
    v_mfma_f32_16x16x32_bf16 v[8:11], v[60:63], v[28:31], v[8:11]
    s_waitcnt lgkmcnt(0)
    v_mfma_f32_16x16x32_bf16 v[12:15], v[76:79], v[44:47], v[12:15]
    s_mov_b32 exec_lo, 0x30003
    s_mov_b32 exec_hi, 0x30003
    s_cmp_eq_u32 s61, 1
    s_nop 4
    s_cbranch_scc1 L_hhalf
    v_pk_add_f32 v[8:9], v[8:9], v[12:13]
    v_pk_add_f32 v[10:11], v[10:11], v[14:15]
L_hhalf:
    v_and_or_b32 v8, v8, v124, s52
    v_and_or_b32 v9, v9, v124, s53
    v_and_or_b32 v10, v10, v124, s54
    v_and_or_b32 v11, v11, v124, s55
    buffer_store_dwordx4 v[8:11], v5, s[12:15], s63 offen
    s_mov_b64 exec, -1
    v_and_b32 v90, 7, v0
    s_bfe_u32 s6, s4, 0x20003
    s_lshl_b32 s7, s5, 3
    s_and_b32 s51, s6, 1
    s_lshl_b32 s51, s51, 5
    s_mul_i32 s6, s6, 448
    s_andn2_b32 s6, s6, 127
    v_add_u32 v90, s7, v90
    s_add_u32 s49, s6, s97
    v_lshrrev_b32 v92, 3, v0
    v_lshl_add_u32 v93, v7, 1, v92
    v_mul_u32_u24 v93, 1792, v93
    v_lshl_add_u32 v93, v90, 4, v93
    s_add_u32 s50, s49, 3584
    s_lshr_b32 s6, s6, 7
    s_add_u32 s6, s6, s5
    s_lshr_b32 s47, s6, 1
    s_add_u32 s6, s62, 3
    s_and_b32 s6, s6, 7
    s_min_u32 s46, s6, 6
    v_lshl_add_u32 v90, v90, 2, v7
    v_lshlrev_b32 v90, 1, v90
    s_lshr_b32 s6, s4, 3
    s_mul_i32 s6, s6, 224
    s_sub_u32 s6, s6, s51
    buffer_load_ushort v94, v90, s[40:43], s6 offen
    v_and_b32 v92, 1, v92
    v_mul_u32_u24 v92, 288, v92
    v_add_u32 v92, v92, v90
    s_lshl_b32 s7, s5, 1
    v_lshrrev_b32 v1, 2, v0
    v_and_b32 v2, 7, v1
    v_xor_b32 v2, s7, v2
    v_lshlrev_b32 v2, 5, v2
    v_lshl_add_u32 v2, v1, 8, v2
    v_and_b32 v1, 3, v0
    v_lshl_add_u32 v2, v1, 3, v2
    v_add_u32 v2, 24576, v2
    v_xor_b32 v3, 32, v2
    v_mul_u32_u24 v88, 288, v6
    v_lshl_add_u32 v88, v7, 3, v88
    s_add_u32 s51, s51, 512
    v_add_u32 v88, s51, v88
    v_lshl_add_u32 v89, v4, 1, v7
    v_lshlrev_b32 v89, 5, v89
    v_lshl_add_u32 v89, v6, 4, v89
    s_lshr_b32 s6, s4, 3
    s_mul_i32 s6, s6, 8320
    s_and_b32 s59, s4, 7
    s_lshl2_add_u32 s7, s59, s5
    s_lshl_b32 s7, s7, 8
    s_add_u32 s6, s6, s7
    s_add_u32 s63, s6, 458752
    s_and_b32 s6, s62, 1
    s_lshr_b32 s7, s62, 1
    s_lshl2_add_u32 s62, s6, s7
    s_mov_b32 s57, 0xbdd2d3e8
    v_mov_b32 v110, 0xc0135761
    v_mov_b32 v52, s52
    v_mov_b32 v53, s53
    v_mov_b32 v54, s54
    v_mov_b32 v55, s55
    buffer_load_dwordx4 v[48:51], v93, s[12:15], s49 offen sc1
    s_cmp_eq_u32 s46, s47
    s_cbranch_scc0 L_hi_44
    buffer_load_dwordx4 v[52:55], v93, s[12:15], s50 offen sc1
L_hi_44:
    s_branch L_h_43c
L_h_43:
    s_sub_u32 s58, s58, 16
    s_cmp_lt_i32 s58, 1047376
    s_cbranch_scc1 L_slow_45
L_bk_46:
    buffer_load_dwordx4 v[48:51], v93, s[12:15], s49 offen sc1
    s_cmp_eq_u32 s46, s47
    s_cbranch_scc0 L_hi_47
    buffer_load_dwordx4 v[52:55], v93, s[12:15], s50 offen sc1
L_hi_47:
L_h_43c:
    s_waitcnt vmcnt(0)
    v_xor_b32 v96, s52, v48
    v_xor_b32 v97, s53, v49
    v_xor_b32 v98, s54, v50
    v_xor_b32 v99, s55, v51
    v_xor_b32 v100, s52, v52
    v_xor_b32 v101, s53, v53
    v_xor_b32 v102, s54, v54
    v_xor_b32 v103, s55, v55
    v_or3_b32 v112, v96, v97, v98
    v_or3_b32 v113, v99, v100, v101
    v_or3_b32 v112, v112, v102, v103
    v_pk_add_f32 v[96:97], v[96:97], v[100:101]
    v_or_b32 v112, v112, v113
    v_pk_add_f32 v[98:99], v[98:99], v[102:103]
    v_cmp_ne_u32_sdwa vcc, v112, v127 src0_sel:BYTE_0 src1_sel:DWORD
    s_cbranch_vccnz L_h_43
    v_mov_b32 v125, 3
    s_mov_b64 exec, 1
    ds_write_b32 v126, v125
    s_mov_b64 exec, -1
    v_lshlrev_b32 v94, 16, v94
    v_permlane32_swap_b32 v96, v98
    v_permlane32_swap_b32 v97, v99
    v_add_f32 v96, v96, v98
    v_add_f32 v97, v97, v99
    s_nop 1
    v_permlane16_swap_b32 v96, v97
    v_add_f32 v96, v96, v97
    v_cvt_pk_bf16_f32 v96, v96, v96
    v_and_b32 v96, 0xffff0000, v96
    v_add_f32 v96, v96, v94
    v_cvt_pk_bf16_f32 v96, v96, v96
    v_and_b32 v96, 0xffff0000, v96
    v_mul_f32 v97, v96, v96
    v_fma_f32 v97, v97, s57, v110
    v_mul_f32 v97, v97, v96
    v_exp_f32 v97, v97
    s_nop 0
    v_add_f32 v97, 1.0, v97
    v_rcp_f32 v97, v97
    s_nop 0
    v_mul_f32 v96, v96, v97
    v_cvt_pk_bf16_f32 v96, v96, v96
    ds_write_b16 v92, v96 offset:512
    v_mov_b32 v125, 4
    s_mov_b64 exec, 1
    ds_write_b32 v126, v125
    s_mov_b64 exec, -1
    s_setprio 2
L_w_48:
    ds_read_b128 v[120:123], v127 offset:0
    s_sub_u32 s58, s58, 1
    s_cbranch_scc1 L_end
    s_waitcnt lgkmcnt(0)
    v_min3_u32 v120, v120, v121, v122
    v_min_u32 v120, v120, v123
    v_cmp_gt_u32 vcc, 40, v120
    s_cbranch_vccnz L_w_48
    ds_read_b64_tr_b16 v[16:17], v2 offset:0
    ds_read_b64_tr_b16 v[32:33], v3 offset:0
    ds_read_b64_tr_b16 v[18:19], v2 offset:4096
    ds_read_b64_tr_b16 v[34:35], v3 offset:4096
    ds_read_b64_tr_b16 v[20:21], v2 offset:8192
    ds_read_b64_tr_b16 v[36:37], v3 offset:8192
    ds_read_b64_tr_b16 v[22:23], v2 offset:12288
    ds_read_b64_tr_b16 v[38:39], v3 offset:12288
    ds_read_b64_tr_b16 v[24:25], v2 offset:16384
    ds_read_b64_tr_b16 v[40:41], v3 offset:16384
    ds_read_b64_tr_b16 v[26:27], v2 offset:20480
    ds_read_b64_tr_b16 v[42:43], v3 offset:20480
    ds_read_b64_tr_b16 v[28:29], v2 offset:24576
    ds_read_b64_tr_b16 v[44:45], v3 offset:24576
    s_setprio 2
L_w_49:
    ds_read_b128 v[120:123], v127 offset:32
    ds_read_b64 v[108:109], v88 offset:192
    ds_read2_b64 v[96:99], v88 offset0:0 offset1:4
    ds_read2_b64 v[100:103], v88 offset0:8 offset1:12
    ds_read2_b64 v[104:107], v88 offset0:16 offset1:20
    s_sub_u32 s58, s58, 1
    s_cbranch_scc1 L_end
    s_waitcnt lgkmcnt(4)
    v_min3_u32 v120, v120, v121, v122
    v_min_u32 v120, v120, v123
    v_cmp_gt_u32 vcc, 4, v120
    s_cbranch_vccnz L_w_49
    s_waitcnt lgkmcnt(3)
    v_mfma_f32_16x16x16_bf16 v[80:83], v[28:29], v[108:109], 0
    v_mfma_f32_16x16x16_bf16 v[84:87], v[44:45], v[108:109], 0
    s_waitcnt lgkmcnt(2)
    v_mfma_f32_16x16x32_bf16 v[8:11], v[16:19], v[96:99], 0
    v_mfma_f32_16x16x32_bf16 v[12:15], v[32:35], v[96:99], 0
    s_waitcnt lgkmcnt(1)
    v_mfma_f32_16x16x32_bf16 v[8:11], v[20:23], v[100:103], v[8:11]
    v_mfma_f32_16x16x32_bf16 v[12:15], v[36:39], v[100:103], v[12:15]
    s_waitcnt lgkmcnt(0)
    v_mfma_f32_16x16x32_bf16 v[8:11], v[24:27], v[104:107], v[8:11]
    v_mfma_f32_16x16x32_bf16 v[12:15], v[40:43], v[104:107], v[12:15]
    v_cndmask_b32 v80, v80, v84, s[98:99]
    v_cndmask_b32 v81, v81, v85, s[98:99]
    v_cndmask_b32 v82, v82, v86, s[98:99]
    v_cndmask_b32 v83, v83, v87, s[98:99]
    s_mov_b32 exec_lo, 0xf000f
    s_mov_b32 exec_hi, 0xf000f
    s_nop 1
    v_cndmask_b32 v8, v8, v12, s[98:99]
    v_cndmask_b32 v9, v9, v13, s[98:99]
    v_cndmask_b32 v10, v10, v14, s[98:99]
    v_cndmask_b32 v11, v11, v15, s[98:99]
    v_pk_add_f32 v[8:9], v[8:9], v[80:81]
    v_pk_add_f32 v[10:11], v[10:11], v[82:83]
    v_and_or_b32 v8, v8, v124, s52
    v_and_or_b32 v9, v9, v124, s53
    v_and_or_b32 v10, v10, v124, s54
    v_and_or_b32 v11, v11, v124, s55
    s_cmp_eq_u32 s59, s62
    s_cbranch_scc1 L_ls_50a
    buffer_store_dwordx4 v[8:11], v89, s[12:15], s63 offen sc1
    s_branch L_ls_50b
L_ls_50a:
    buffer_store_dwordx4 v[8:11], v89, s[12:15], s63 offen
L_ls_50b:
    s_mov_b64 exec, -1
    s_waitcnt vmcnt(0)
    v_mov_b32 v125, 5
    s_mov_b64 exec, 1
    ds_write_b32 v126, v125
    s_mov_b64 exec, -1
L_fin:
    s_setprio 0
L_w_51:
    ds_read_b32 v120, v127 offset:48
    ds_read_b32 v119, v127 offset:76
    s_sub_u32 s58, s58, 1
    s_cbranch_scc1 L_end
    s_waitcnt lgkmcnt(1)
    v_cmp_gt_u32 vcc, 1, v120
    s_cbranch_vccnz L_w_51
    s_waitcnt lgkmcnt(0)
    v_cmp_ne_u32 vcc, 0, v119
L_fin2:
    s_cbranch_vccz L_stamp
    s_waitcnt vmcnt(0)
    buffer_wbl2 sc1
    s_waitcnt vmcnt(0)
L_stamp:
L_end:
    s_endpgm
L_slow_4:
    s_sub_u32 s58, s58, 256
    s_cmp_lt_i32 s58, 0
    s_cbranch_scc1 L_end
    buffer_wbl2 sc1
    s_waitcnt vmcnt(0)
    buffer_inv sc1
    s_waitcnt vmcnt(0)
    s_sleep 32
    s_branch L_bk_5
L_slow_15:
    s_sub_u32 s58, s58, 256
    s_cmp_lt_i32 s58, 0
    s_cbranch_scc1 L_end
    buffer_wbl2 sc1
    s_waitcnt vmcnt(0)
    buffer_inv sc1
    s_waitcnt vmcnt(0)
    s_sleep 32
    s_branch L_bk_16
L_slow_24:
    s_sub_u32 s58, s58, 256
    s_cmp_lt_i32 s58, 0
    s_cbranch_scc1 L_end
    buffer_wbl2 sc1
    s_waitcnt vmcnt(0)
    buffer_inv sc1
    s_waitcnt vmcnt(0)
    s_sleep 32
    s_branch L_bk_25
L_slow_30:
    s_sub_u32 s58, s58, 256
    s_cmp_lt_i32 s58, 0
    s_cbranch_scc1 L_end
    buffer_wbl2 sc1
    s_waitcnt vmcnt(0)
    buffer_inv sc1
    s_waitcnt vmcnt(0)
    s_sleep 32
    s_branch L_bk_31
L_slow_37:
    s_sub_u32 s58, s58, 256
    s_cmp_lt_i32 s58, 0
    s_cbranch_scc1 L_end
    buffer_wbl2 sc1
    s_waitcnt vmcnt(0)
    buffer_inv sc1
    s_waitcnt vmcnt(0)
    s_sleep 32
    s_branch L_bk_38
L_slow_45:
    s_sub_u32 s58, s58, 256
    s_cmp_lt_i32 s58, 0
    s_cbranch_scc1 L_end
    buffer_wbl2 sc1
    s_waitcnt vmcnt(0)
    buffer_inv sc1
    s_waitcnt vmcnt(0)
    s_sleep 32
    s_branch L_bk_46
.section .rodata,"a"
.p2align 6
.amdhsa_kernel recurrent_scan__sliding_block_cached__mixer_channel_mlp__decode_kernel
  .amdhsa_next_free_vgpr 128
  .amdhsa_next_free_sgpr 102
  .amdhsa_accum_offset 128
  .amdhsa_group_segment_fixed_size 0
  .amdhsa_kernarg_size 104
  .amdhsa_user_sgpr_count 2
  .amdhsa_user_sgpr_kernarg_segment_ptr 1
  .amdhsa_system_sgpr_workgroup_id_x 1
.end_amdhsa_kernel
```
